```python
import torch

def _softmax(x, axis=-1):
    return torch.softmax(x, dim=axis)
def _gelu(x):
    return torch.nn.functional.gelu(x, approximate="tanh")
def _silu(x):
    return torch.nn.functional.silu(x)
def _sigmoid(x):
    return torch.sigmoid(x)
def _layernorm(x, axis=-1, eps=1e-5):
    m = x.mean(dim=axis, keepdim=True)
    v = x.var(dim=axis, keepdim=True, unbiased=False)
    return (x - m) / torch.sqrt(v + eps)
def _scatter_add(tgt, idx, src, axis=0):
    return tgt.clone().index_add_(axis, idx, src)
def _segment_sum(src, seg, n):
    out = torch.zeros((n,) + src.shape[1:], dtype=src.dtype)
    return out.index_add_(0, seg, src)
def _pad(x, pw):
    flat = tuple(v for pair in reversed(pw) for v in pair)
    return torch.nn.functional.pad(x, flat)

kernel_name = 'parallel_sum__softmax_full_mha__mixer_channel_mlp__prompt'

def setup_inputs():

    _w = (lambda a: (lambda t: t.to(torch.bfloat16) if t.is_floating_point() else t)(torch.as_tensor(a)))
    def _A_setup():
        B, S, D = 1, 2048, 512
        return {
            "x": _w((lambda *s: torch.randn(*s, dtype=torch.bfloat16) * 0.05)(B, S, D)),
            "wqkv": _w((lambda *s: torch.randn(*s, dtype=torch.bfloat16) * 0.05)(D, 3 * D)),
            "wo": _w((lambda *s: torch.randn(*s, dtype=torch.bfloat16) * 0.05)(D, D)),
        }
    _A_in = _A_setup()

    def _B_setup():
        B, S, D, F = 1, 2048, 512, 1376
        return {
            "x": _w((lambda *s: torch.randn(*s, dtype=torch.bfloat16) * 0.05)(B, S, D)),
            "w1": _w((lambda *s: torch.randn(*s, dtype=torch.bfloat16) * 3.2)(D, F) * (D ** -0.5)),
            "b1": _w((lambda *s: torch.randn(*s, dtype=torch.bfloat16) * 1.6)(F)),
            "w2": _w((lambda *s: torch.randn(*s, dtype=torch.bfloat16) * 0.05)(F, D) * (F ** -0.5)),
            "b2": _w((lambda *s: torch.randn(*s, dtype=torch.bfloat16) * 0.1)(D)),
        }
    _B_in = _B_setup()

    return {
        "A_x": _A_in["x"],
        "A_wqkv": _A_in["wqkv"],
        "A_wo": _A_in["wo"],
        "B_x": _B_in["x"],
        "B_w1": _B_in["w1"],
        "B_b1": _B_in["b1"],
        "B_w2": _B_in["w2"],
        "B_b2": _B_in["b2"],
    }

def reference(A_x, A_wqkv, A_wo, B_x, B_w1, B_b1, B_w2, B_b2):
    def _A_ref(x, wqkv, wo):
        B, S, D = x.shape
        H = 32; Dh = D // H
        qkv = (lambda x, *d: x.permute(*d))((x @ wqkv).reshape(B, S, 3, H, Dh), 2, 0, 3, 1, 4)
        q, k, v = qkv[0], qkv[1], qkv[2]
        scale = Dh ** -0.5
        scores = torch.einsum("bhqd,bhkd->bhqk", q, k) * scale
        p = _softmax(scores, axis=-1)
        o = torch.einsum("bhqk,bhkd->bhqd", p, v)
        return (lambda x, *d: x.permute(*d))(o, 0, 2, 1, 3).reshape(B, S, D) @ wo

    def _B_ref(x, w1, b1, w2, b2):
        y = _layernorm(x, axis=-1)
        h = _gelu(torch.einsum("bsd,df->bsf", y, w1) + b1)
        return torch.einsum("bsf,fd->bsd", h, w2) + b2

    x = A_x
    xn = _layernorm(x, axis=-1)
    return x + _A_ref(xn, A_wqkv, A_wo) + _B_ref(xn, B_w1, B_b1, B_w2, B_b2)
```

```asm
; @launch grid=(256,1,1) block=(512,1,1) lds=163840
.amdgcn_target "amdgcn-amd-amdhsa--gfx950"
.text
.globl parallel_sum__softmax_full_mha__mixer_channel_mlp__prompt_kernel
.p2align 8
.type parallel_sum__softmax_full_mha__mixer_channel_mlp__prompt_kernel,@function
parallel_sum__softmax_full_mha__mixer_channel_mlp__prompt_kernel:
K_START:
  s_cmp_ge_u32 s2, 256
  s_cbranch_scc1 K_END
  s_load_dwordx16 s[4:19], s[0:1], 0
  s_load_dwordx2 s[20:21], s[0:1], 64
  s_load_dwordx2 s[22:23], s[0:1], 80
  v_and_b32 v1, 63, v0
  v_lshrrev_b32 v2, 6, v0
  s_and_b32 s48, s2, 7
  v_readfirstlane_b32 s36, v2
  s_lshr_b32 s49, s2, 3
  s_and_b32 s50, s48, 1
  s_lshr_b32 s51, s48, 1
  s_lshl_b32 s50, s50, 3
  s_and_b32 s52, s49, 7
  s_add_u32 s38, s50, s52
  s_lshl_b32 s51, s51, 2
  s_lshr_b32 s52, s49, 3
  s_add_u32 s39, s51, s52
  s_and_b32 s37, s36, 3
  v_and_b32 v3, 31, v1
  v_lshrrev_b32 v4, 5, v1
  s_cmp_ge_u32 s36, 4
  s_cbranch_scc1 K_G1
  s_getpc_b64 s[62:63]
PF_0:
  s_sub_u32 s62, s62, PF_0-K_START
  s_subb_u32 s63, s63, 0
  s_lshr_b32 s60, s2, 3
  s_and_b32 s60, s60, 7
  s_lshl_b32 s60, s60, 2
  s_add_u32 s60, s60, s37
  s_lshl_b32 s60, s60, 10
  v_lshlrev_b32 v9, 4, v1
  v_add_u32 v9, s60, v9
  v_min_u32 v10, K_END-K_START-16, v9
  global_load_dwordx4 v[200:203], v10, s[62:63]
  v_add_u32 v9, 0x8000, v9
  v_min_u32 v10, K_END-K_START-16, v9
  global_load_dwordx4 v[204:207], v10, s[62:63]
  s_branch K_G0
K_G1:
  s_setprio 2
  v_lshrrev_b32 v20, 3, v1
  v_and_b32 v21, 7, v1
  v_lshrrev_b32 v22, 4, v1
  v_xor_b32 v21, v21, v22
  v_lshlrev_b32 v20, 10, v20
  v_lshlrev_b32 v22, 4, v21
  v_add_u32 v2, v20, v22
  v_xor_b32 v22, 64, v22
  v_add_u32 v22, 7168, v22
  v_add_u32 v18, v20, v22
  v_add_u32 v19, 14336, v2
  v_add_u32 v20, 14336, v18
  s_lshl_b32 s50, s38, 17
  s_lshl_b32 s51, s37, 15
  s_add_u32 s50, s50, s51
  s_lshl_b32 s53, s37, 12
  s_and_b32 s58, s39, 3
  s_lshl_b32 s58, s58, 1
  s_add_u32 s58, s58, s38
  s_and_b32 s58, s58, 7
  s_waitcnt lgkmcnt(0)
  s_mov_b32 s24, s4
  s_mov_b32 s25, s5
  s_mov_b32 s26, 2097152
  s_mov_b32 s27, 0x00020000
  s_add_u32 s61, s58, 0
  s_and_b32 s61, s61, 7
  s_add_u32 m0, s53, 0
  s_lshl_b32 s55, s61, 7
  s_add_u32 s55, s55, s50
  buffer_load_dwordx4 v2, s[24:27], s55 offen offset:0 lds
  buffer_load_dwordx4 v18, s[24:27], s55 offen offset:1024 lds
  buffer_load_dwordx4 v19, s[24:27], s55 offen offset:2048 lds
  buffer_load_dwordx4 v20, s[24:27], s55 offen offset:3072 lds
  v_add_u32 v27, 0, v1
  v_mul_u32_u24 v28, 43691, v27
  v_lshrrev_b32 v28, 19, v28
  v_mul_u32_u24 v29, 12, v28
  v_sub_u32 v29, v27, v29
  v_lshrrev_b32 v30, 2, v29
  v_lshlrev_b32 v30, 10, v30
  v_and_b32 v31, 3, v29
  v_lshlrev_b32 v31, 4, v31
  v_mul_u32_u24 v32, 3072, v28
  v_add3_u32 v21, v32, v30, v31
  v_mov_b32 v33, v28
  v_mov_b32 v34, v29
  v_add_u32 v27, 64, v1
  v_mul_u32_u24 v28, 43691, v27
  v_lshrrev_b32 v28, 19, v28
  v_mul_u32_u24 v29, 12, v28
  v_sub_u32 v29, v27, v29
  v_lshrrev_b32 v30, 2, v29
  v_lshlrev_b32 v30, 10, v30
  v_and_b32 v31, 3, v29
  v_lshlrev_b32 v31, 4, v31
  v_mul_u32_u24 v32, 3072, v28
  v_add3_u32 v22, v32, v30, v31
  v_subrev_u32 v22, 1024, v22
  v_mov_b32 v35, v28
  v_mov_b32 v36, v29
  v_add_u32 v27, 128, v1
  v_mul_u32_u24 v28, 43691, v27
  v_lshrrev_b32 v28, 19, v28
  v_mul_u32_u24 v29, 12, v28
  v_sub_u32 v29, v27, v29
  v_lshrrev_b32 v30, 2, v29
  v_lshlrev_b32 v30, 10, v30
  v_and_b32 v31, 3, v29
  v_lshlrev_b32 v31, 4, v31
  v_mul_u32_u24 v32, 3072, v28
  v_add3_u32 v23, v32, v30, v31
  v_subrev_u32 v23, 2048, v23
  v_mov_b32 v37, v28
  v_mov_b32 v38, v29
  s_mul_i32 s51, s37, 49152
  s_lshl_b32 s52, s39, 6
  s_add_u32 s51, s51, s52
  s_mul_i32 s54, s37, 3072
  s_mov_b32 s32, s6
  s_mov_b32 s33, s7
  s_mov_b32 s34, 1572864
  s_mov_b32 s35, 0x00020000
  s_add_u32 s61, s58, 0
  s_and_b32 s61, s61, 7
  s_add_u32 m0, s54, 16384
  s_mul_i32 s55, s61, 196608
  s_add_u32 s55, s55, s51
  buffer_load_dwordx4 v21, s[32:35], s55 offen offset:0 lds
  buffer_load_dwordx4 v22, s[32:35], s55 offen offset:1024 lds
  buffer_load_dwordx4 v23, s[32:35], s55 offen offset:2048 lds
  v_mul_u32_u24 v32, 2752, v33
  v_lshlrev_b32 v31, 4, v34
  v_add_u32 v24, v32, v31
  v_mul_u32_u24 v32, 2752, v35
  v_lshlrev_b32 v31, 4, v36
  v_add_u32 v25, v32, v31
  v_subrev_u32 v25, 1024, v25
  v_mul_u32_u24 v32, 2752, v37
  v_lshlrev_b32 v31, 4, v38
  v_add_u32 v26, v32, v31
  v_subrev_u32 v26, 2048, v26
  s_mul_i32 s52, s39, 3
  s_lshl_b32 s56, s39, 1
  s_add_u32 s56, s56, 11
  s_cmp_lt_u32 s39, 11
  s_cselect_b32 s48, s52, s56
  s_cselect_b32 s49, 3, 2
  s_mul_i32 s52, s37, 44032
  s_lshl_b32 s56, s48, 6
  s_add_u32 s52, s52, s56
  s_add_u32 s61, s58, 1
  s_and_b32 s61, s61, 7
  s_add_u32 m0, s53, 28672
  s_lshl_b32 s55, s61, 7
  s_add_u32 s55, s55, s50
  buffer_load_dwordx4 v2, s[24:27], s55 offen offset:0 lds
  buffer_load_dwordx4 v18, s[24:27], s55 offen offset:1024 lds
  buffer_load_dwordx4 v19, s[24:27], s55 offen offset:2048 lds
  buffer_load_dwordx4 v20, s[24:27], s55 offen offset:3072 lds
  s_add_u32 s61, s58, 1
  s_and_b32 s61, s61, 7
  s_add_u32 m0, s54, 45056
  s_mul_i32 s55, s61, 196608
  s_add_u32 s55, s55, s51
  buffer_load_dwordx4 v21, s[32:35], s55 offen offset:0 lds
  buffer_load_dwordx4 v22, s[32:35], s55 offen offset:1024 lds
  buffer_load_dwordx4 v23, s[32:35], s55 offen offset:2048 lds
  s_mov_b32 s40, s12
  s_mov_b32 s41, s13
  s_mov_b32 s42, 1409024
  s_mov_b32 s43, 0x00020000
  s_mov_b32 s28, s22
  s_mov_b32 s29, s23
  s_mov_b32 s30, 16777216
  s_mov_b32 s31, 0x00020000
  s_mov_b32 s44, s14
  s_mov_b32 s45, s15
  s_mov_b32 s46, 2752
  s_mov_b32 s47, 0x00020000
  s_load_dwordx2 s[64:65], s[22:23], 0
  v_bfe_u32 v5, v1, 1, 3
  v_xor_b32 v5, v5, v4
  v_lshlrev_b32 v5, 4, v5
  s_lshl_b32 s3, s37, 12
  v_lshlrev_b32 v6, 7, v3
  v_add3_u32 v12, v6, v5, s3
  v_xor_b32 v13, 32, v12
  v_xor_b32 v14, 64, v12
  v_xor_b32 v15, 0x60, v12
  v_lshlrev_b32 v6, 3, v4
  v_bfe_u32 v7, v1, 2, 2
  v_add_u32 v6, v6, v7
  v_mul_u32_u24 v6, 192, v6
  v_bfe_u32 v7, v1, 4, 1
  v_lshlrev_b32 v7, 5, v7
  v_and_b32 v8, 3, v1
  v_lshlrev_b32 v8, 3, v8
  v_add3_u32 v16, v6, v7, v8
  v_lshlrev_b32 v27, 2, v1
  buffer_load_dword v31, v27, s[44:47], s56 offen
  s_cmp_eq_u32 s37, 3
  s_cselect_b32 s57, 0, s37
  s_lshl_b32 s3, s57, 6
  s_add_u32 s3, s3, 16384
  v_add_u32 v17, s3, v16
  v_and_b32 v27, 15, v1
  v_bfe_u32 v28, v1, 4, 1
  v_cmp_eq_u32 vcc, v27, v28
  v_mov_b32 v29, 0x3f803f80
  s_nop 0
  v_cndmask_b32 v112, 0, v29, vcc
  v_mov_b32 v113, v112
  v_mov_b32 v114, v112
  v_mov_b32 v115, v112
  v_mov_b32 v8, v29
  v_mov_b32 v9, v29
  v_mov_b32 v10, v29
  v_mov_b32 v11, v29
  v_and_b32 v30, 1, v1
  v_cmp_eq_u32 vcc, 1, v30
  v_mov_b32 v30, 0x44444444
  v_mov_b32 v32, 0xeeeeeeee
  v_cndmask_b32 v99, v30, v32, vcc
  v_and_b32 v30, 14, v1
  v_cmp_eq_u32 vcc, 0, v30
  v_cmp_eq_u32 s[66:67], 2, v30
  s_nop 0
  v_cndmask_b32 v100, 0, v29, vcc
  v_cndmask_b32 v102, 0, v29, s[66:67]
  v_mov_b32 v101, v100
  v_mov_b32 v103, v102
  v_mov_b32 v116, 0
  v_mov_b32 v117, 0
  v_mov_b32 v118, 0
  v_mov_b32 v119, 0
  v_mov_b32 v120, 0
  v_mov_b32 v121, 0
  v_mov_b32 v122, 0
  v_mov_b32 v123, 0
  v_mov_b32 v124, 0
  v_mov_b32 v125, 0
  v_mov_b32 v126, 0
  v_mov_b32 v127, 0
  v_mov_b32 v104, 0
  v_mov_b32 v105, 0
  v_mov_b32 v106, 0
  v_mov_b32 v107, 0
  v_mov_b32 v108, 0
  v_mov_b32 v109, 0
  v_mov_b32 v110, 0
  v_mov_b32 v111, 0
  v_lshrrev_b32 v28, 4, v1
  v_bfe_u32 v29, v1, 1, 3
  v_xor_b32 v28, v28, v29
  v_lshlrev_b32 v28, 4, v28
  v_lshlrev_b32 v27, 7, v27
  s_lshl_b32 s3, s37, 12
  v_add3_u32 v5, v27, v28, s3
  v_xor_b32 v6, 64, v5
  v_and_b32 v27, 3, v1
  v_cmp_eq_u32 s[66:67], 1, v27
  v_cmp_eq_u32 s[68:69], 2, v27
  v_cmp_eq_u32 s[44:45], 3, v27
  s_mov_b32 s46, 0x00f0000f
  s_mov_b32 s47, 0xf0000f00
  v_and_b32 v28, 15, v1
  v_lshlrev_b32 v28, 2, v28
  s_lshl_b32 s3, s37, 7
  v_add_u32 v28, s3, v28
  v_add_u32 v28, 155648, v28
  v_lshlrev_b32 v29, 2, v1
  s_lshl_b32 s55, s57, 7
  s_add_u32 s55, s55, 156672
  v_add_u32 v29, s55, v29
  s_waitcnt lgkmcnt(0)
  s_add_u32 s64, s64, 0x7f4a7c15
  s_addc_u32 s65, s65, 0x9e3779b9
  s_mov_b32 s59, 28672
  s_mov_b32 s60, 0xfffe4000
  s_waitcnt vmcnt(8)
  s_barrier
  ds_read_b128 v[56:59], v5 offset:0
  ds_read_b128 v[60:63], v6 offset:0
  ds_read_b128 v[64:67], v5 offset:2048
  ds_read_b128 v[68:71], v6 offset:2048
  ds_read_b64_tr_b16 v[40:41], v17 offset:0
  ds_read_b64_tr_b16 v[42:43], v17 offset:768
  ds_read_b64_tr_b16 v[44:45], v17 offset:3072
  ds_read_b64_tr_b16 v[46:47], v17 offset:3840
  ds_read_b64_tr_b16 v[48:49], v17 offset:6144
  ds_read_b64_tr_b16 v[50:51], v17 offset:6912
  ds_read_b64_tr_b16 v[52:53], v17 offset:9216
  ds_read_b64_tr_b16 v[54:55], v17 offset:9984
  s_add_u32 s61, s58, 2
  s_and_b32 s61, s61, 7
  s_add_u32 m0, s53, 57344
  s_lshl_b32 s55, s61, 7
  s_add_u32 s55, s55, s50
  buffer_load_dwordx4 v2, s[24:27], s55 offen offset:0 lds
  buffer_load_dwordx4 v18, s[24:27], s55 offen offset:1024 lds
  s_waitcnt lgkmcnt(8)
  v_smfmac_f32_16x16x64_bf16 v[116:119], v[8:11], v[56:63], v99
  ds_read_b128 v[128:131], v12
  buffer_load_dwordx4 v19, s[24:27], s55 offen offset:2048 lds
  v_mfma_f32_16x16x32_bf16 v[124:127], v[56:59], v[56:59], v[124:127]
  ds_read_b128 v[132:135], v13
  buffer_load_dwordx4 v20, s[24:27], s55 offen offset:3072 lds
  s_add_u32 s61, s58, 2
  s_and_b32 s61, s61, 7
  s_add_u32 m0, s54, 73728
  s_mul_i32 s55, s61, 196608
  s_add_u32 s55, s55, s51
  v_mfma_f32_16x16x32_bf16 v[124:127], v[60:63], v[60:63], v[124:127]
  v_smfmac_f32_16x16x64_bf16 v[120:123], v[8:11], v[64:71], v99
  buffer_load_dwordx4 v21, s[32:35], s55 offen offset:0 lds
  ds_read_b128 v[136:139], v14
  v_mfma_f32_16x16x32_bf16 v[104:107], v[64:67], v[64:67], v[104:107]
  buffer_load_dwordx4 v22, s[32:35], s55 offen offset:1024 lds
  ds_read_b128 v[140:143], v15
  v_mfma_f32_16x16x32_bf16 v[104:107], v[68:71], v[68:71], v[104:107]
  buffer_load_dwordx4 v23, s[32:35], s55 offen offset:2048 lds
  s_waitcnt lgkmcnt(4)
  v_smfmac_f32_16x16x64_bf16 v[108:111], v[100:103], v[40:47], v99
  v_smfmac_f32_16x16x64_bf16 v[108:111], v[100:103], v[48:55], v99
  v_add_u32 v12, s59, v12
  v_add_u32 v13, s59, v13
  v_add_u32 v14, s59, v14
  v_add_u32 v15, s59, v15
  v_add_u32 v17, s59, v17
  v_add_u32 v5, s59, v5
  v_add_u32 v6, s59, v6
  s_waitcnt vmcnt(8)
  s_barrier
  ds_read_b128 v[56:59], v5 offset:0
  ds_read_b128 v[60:63], v6 offset:0
  ds_read_b128 v[64:67], v5 offset:2048
  ds_read_b128 v[68:71], v6 offset:2048
  ds_read_b64_tr_b16 v[40:41], v17 offset:0
  ds_read_b64_tr_b16 v[42:43], v17 offset:768
  ds_read_b64_tr_b16 v[44:45], v17 offset:3072
  ds_read_b64_tr_b16 v[46:47], v17 offset:3840
  ds_read_b64_tr_b16 v[48:49], v17 offset:6144
  ds_read_b64_tr_b16 v[50:51], v17 offset:6912
  ds_read_b64_tr_b16 v[52:53], v17 offset:9216
  ds_read_b64_tr_b16 v[54:55], v17 offset:9984
  s_add_u32 s61, s58, 3
  s_and_b32 s61, s61, 7
  s_add_u32 m0, s53, 86016
  s_lshl_b32 s55, s61, 7
  s_add_u32 s55, s55, s50
  buffer_load_dwordx4 v2, s[24:27], s55 offen offset:0 lds
  buffer_load_dwordx4 v18, s[24:27], s55 offen offset:1024 lds
  s_waitcnt lgkmcnt(8)
  v_smfmac_f32_16x16x64_bf16 v[116:119], v[8:11], v[56:63], v99
  ds_read_b128 v[144:147], v12
  buffer_load_dwordx4 v19, s[24:27], s55 offen offset:2048 lds
  v_mfma_f32_16x16x32_bf16 v[124:127], v[56:59], v[56:59], v[124:127]
  ds_read_b128 v[148:151], v13
  buffer_load_dwordx4 v20, s[24:27], s55 offen offset:3072 lds
  s_add_u32 s61, s58, 3
  s_and_b32 s61, s61, 7
  s_add_u32 m0, s54, 102400
  s_mul_i32 s55, s61, 196608
  s_add_u32 s55, s55, s51
  v_mfma_f32_16x16x32_bf16 v[124:127], v[60:63], v[60:63], v[124:127]
  v_smfmac_f32_16x16x64_bf16 v[120:123], v[8:11], v[64:71], v99
  buffer_load_dwordx4 v21, s[32:35], s55 offen offset:0 lds
  ds_read_b128 v[152:155], v14
  v_mfma_f32_16x16x32_bf16 v[104:107], v[64:67], v[64:67], v[104:107]
  buffer_load_dwordx4 v22, s[32:35], s55 offen offset:1024 lds
  ds_read_b128 v[156:159], v15
  v_mfma_f32_16x16x32_bf16 v[104:107], v[68:71], v[68:71], v[104:107]
  buffer_load_dwordx4 v23, s[32:35], s55 offen offset:2048 lds
  s_waitcnt lgkmcnt(4)
  v_smfmac_f32_16x16x64_bf16 v[108:111], v[100:103], v[40:47], v99
  v_smfmac_f32_16x16x64_bf16 v[108:111], v[100:103], v[48:55], v99
  v_add_u32 v12, s59, v12
  v_add_u32 v13, s59, v13
  v_add_u32 v14, s59, v14
  v_add_u32 v15, s59, v15
  v_add_u32 v17, s59, v17
  v_add_u32 v5, s59, v5
  v_add_u32 v6, s59, v6
  s_waitcnt vmcnt(7)
  s_barrier
  ds_read_b128 v[56:59], v5 offset:0
  ds_read_b128 v[60:63], v6 offset:0
  ds_read_b128 v[64:67], v5 offset:2048
  ds_read_b128 v[68:71], v6 offset:2048
  ds_read_b64_tr_b16 v[40:41], v17 offset:0
  ds_read_b64_tr_b16 v[42:43], v17 offset:768
  ds_read_b64_tr_b16 v[44:45], v17 offset:3072
  ds_read_b64_tr_b16 v[46:47], v17 offset:3840
  ds_read_b64_tr_b16 v[48:49], v17 offset:6144
  ds_read_b64_tr_b16 v[50:51], v17 offset:6912
  ds_read_b64_tr_b16 v[52:53], v17 offset:9216
  ds_read_b64_tr_b16 v[54:55], v17 offset:9984
  s_add_u32 s61, s58, 4
  s_and_b32 s61, s61, 7
  s_add_u32 m0, s53, 114688
  s_lshl_b32 s55, s61, 7
  s_add_u32 s55, s55, s50
  buffer_load_dwordx4 v2, s[24:27], s55 offen offset:0 lds
  buffer_load_dwordx4 v18, s[24:27], s55 offen offset:1024 lds
  s_waitcnt lgkmcnt(8)
  v_smfmac_f32_16x16x64_bf16 v[116:119], v[8:11], v[56:63], v99
  ds_read_b128 v[160:163], v12
  buffer_load_dwordx4 v19, s[24:27], s55 offen offset:2048 lds
  v_mfma_f32_16x16x32_bf16 v[124:127], v[56:59], v[56:59], v[124:127]
  ds_read_b128 v[164:167], v13
  buffer_load_dwordx4 v20, s[24:27], s55 offen offset:3072 lds
  s_add_u32 s61, s58, 4
  s_and_b32 s61, s61, 7
  s_add_u32 m0, s54, 131072
  s_mul_i32 s55, s61, 196608
  s_add_u32 s55, s55, s51
  v_mfma_f32_16x16x32_bf16 v[124:127], v[60:63], v[60:63], v[124:127]
  v_smfmac_f32_16x16x64_bf16 v[120:123], v[8:11], v[64:71], v99
  buffer_load_dwordx4 v21, s[32:35], s55 offen offset:0 lds
  ds_read_b128 v[168:171], v14
  v_mfma_f32_16x16x32_bf16 v[104:107], v[64:67], v[64:67], v[104:107]
  buffer_load_dwordx4 v22, s[32:35], s55 offen offset:1024 lds
  ds_read_b128 v[172:175], v15
  v_mfma_f32_16x16x32_bf16 v[104:107], v[68:71], v[68:71], v[104:107]
  buffer_load_dwordx4 v23, s[32:35], s55 offen offset:2048 lds
  s_add_u32 s61, s58, 0
  s_and_b32 s61, s61, 7
  s_add_u32 m0, s54, 143360
  s_mul_i32 s55, s61, 176128
  s_add_u32 s55, s55, s52
  s_waitcnt lgkmcnt(4)
  v_smfmac_f32_16x16x64_bf16 v[108:111], v[100:103], v[40:47], v99
  buffer_load_dwordx4 v24, s[40:43], s55 offen offset:0 lds
  v_smfmac_f32_16x16x64_bf16 v[108:111], v[100:103], v[48:55], v99
  v_add_u32 v12, s59, v12
  buffer_load_dwordx4 v25, s[40:43], s55 offen offset:1024 lds
  v_add_u32 v13, s59, v13
  v_add_u32 v14, s59, v14
  buffer_load_dwordx4 v26, s[40:43], s55 offen offset:2048 lds
  v_add_u32 v15, s59, v15
  v_add_u32 v17, s59, v17
  v_add_u32 v5, s59, v5
  v_add_u32 v6, s59, v6
  s_waitcnt vmcnt(10)
  s_barrier
  ds_read_b128 v[56:59], v5 offset:0
  ds_read_b128 v[60:63], v6 offset:0
  ds_read_b128 v[64:67], v5 offset:2048
  ds_read_b128 v[68:71], v6 offset:2048
  ds_read_b64_tr_b16 v[40:41], v17 offset:0
  ds_read_b64_tr_b16 v[42:43], v17 offset:768
  ds_read_b64_tr_b16 v[44:45], v17 offset:3072
  ds_read_b64_tr_b16 v[46:47], v17 offset:3840
  ds_read_b64_tr_b16 v[48:49], v17 offset:6144
  ds_read_b64_tr_b16 v[50:51], v17 offset:6912
  ds_read_b64_tr_b16 v[52:53], v17 offset:9216
  ds_read_b64_tr_b16 v[54:55], v17 offset:9984
  s_add_u32 s61, s58, 5
  s_and_b32 s61, s61, 7
  s_add_u32 m0, s53, 0
  s_lshl_b32 s55, s61, 7
  s_add_u32 s55, s55, s50
  buffer_load_dwordx4 v2, s[24:27], s55 offen offset:0 lds
  buffer_load_dwordx4 v18, s[24:27], s55 offen offset:1024 lds
  s_waitcnt lgkmcnt(8)
  v_smfmac_f32_16x16x64_bf16 v[116:119], v[8:11], v[56:63], v99
  ds_read_b128 v[176:179], v12
  buffer_load_dwordx4 v19, s[24:27], s55 offen offset:2048 lds
  v_mfma_f32_16x16x32_bf16 v[124:127], v[56:59], v[56:59], v[124:127]
  ds_read_b128 v[180:183], v13
  buffer_load_dwordx4 v20, s[24:27], s55 offen offset:3072 lds
  s_add_u32 s61, s58, 5
  s_and_b32 s61, s61, 7
  s_add_u32 m0, s54, 16384
  s_mul_i32 s55, s61, 196608
  s_add_u32 s55, s55, s51
  v_mfma_f32_16x16x32_bf16 v[124:127], v[60:63], v[60:63], v[124:127]
  v_smfmac_f32_16x16x64_bf16 v[120:123], v[8:11], v[64:71], v99
  buffer_load_dwordx4 v21, s[32:35], s55 offen offset:0 lds
  ds_read_b128 v[184:187], v14
  v_mfma_f32_16x16x32_bf16 v[104:107], v[64:67], v[64:67], v[104:107]
  buffer_load_dwordx4 v22, s[32:35], s55 offen offset:1024 lds
  ds_read_b128 v[188:191], v15
  v_mfma_f32_16x16x32_bf16 v[104:107], v[68:71], v[68:71], v[104:107]
  buffer_load_dwordx4 v23, s[32:35], s55 offen offset:2048 lds
  s_waitcnt lgkmcnt(4)
  v_smfmac_f32_16x16x64_bf16 v[108:111], v[100:103], v[40:47], v99
  v_smfmac_f32_16x16x64_bf16 v[108:111], v[100:103], v[48:55], v99
  v_add_u32 v12, s59, v12
  v_add_u32 v13, s59, v13
  v_add_u32 v14, s59, v14
  v_add_u32 v15, s59, v15
  v_add_u32 v17, s59, v17
  v_add_u32 v5, s59, v5
  v_add_u32 v6, s59, v6
  s_waitcnt vmcnt(10)
  s_barrier
  ds_read_b128 v[56:59], v5 offset:0
  ds_read_b128 v[60:63], v6 offset:0
  ds_read_b128 v[64:67], v5 offset:2048
  ds_read_b128 v[68:71], v6 offset:2048
  ds_read_b64_tr_b16 v[40:41], v17 offset:0
  ds_read_b64_tr_b16 v[42:43], v17 offset:768
  ds_read_b64_tr_b16 v[44:45], v17 offset:3072
  ds_read_b64_tr_b16 v[46:47], v17 offset:3840
  ds_read_b64_tr_b16 v[48:49], v17 offset:6144
  ds_read_b64_tr_b16 v[50:51], v17 offset:6912
  ds_read_b64_tr_b16 v[52:53], v17 offset:9216
  ds_read_b64_tr_b16 v[54:55], v17 offset:9984
  s_add_u32 s61, s58, 6
  s_and_b32 s61, s61, 7
  s_add_u32 m0, s53, 28672
  s_lshl_b32 s55, s61, 7
  s_add_u32 s55, s55, s50
  buffer_load_dwordx4 v2, s[24:27], s55 offen offset:0 lds
  buffer_load_dwordx4 v18, s[24:27], s55 offen offset:1024 lds
  s_waitcnt lgkmcnt(8)
  v_smfmac_f32_16x16x64_bf16 v[116:119], v[8:11], v[56:63], v99
  ds_read_b128 v[192:195], v12
  buffer_load_dwordx4 v19, s[24:27], s55 offen offset:2048 lds
  v_mfma_f32_16x16x32_bf16 v[124:127], v[56:59], v[56:59], v[124:127]
  ds_read_b128 v[196:199], v13
  buffer_load_dwordx4 v20, s[24:27], s55 offen offset:3072 lds
  s_add_u32 s61, s58, 6
  s_and_b32 s61, s61, 7
  s_add_u32 m0, s54, 45056
  s_mul_i32 s55, s61, 196608
  s_add_u32 s55, s55, s51
  v_mfma_f32_16x16x32_bf16 v[124:127], v[60:63], v[60:63], v[124:127]
  v_smfmac_f32_16x16x64_bf16 v[120:123], v[8:11], v[64:71], v99
  buffer_load_dwordx4 v21, s[32:35], s55 offen offset:0 lds
  ds_read_b128 v[200:203], v14
  v_mfma_f32_16x16x32_bf16 v[104:107], v[64:67], v[64:67], v[104:107]
  buffer_load_dwordx4 v22, s[32:35], s55 offen offset:1024 lds
  ds_read_b128 v[204:207], v15
  v_mfma_f32_16x16x32_bf16 v[104:107], v[68:71], v[68:71], v[104:107]
  buffer_load_dwordx4 v23, s[32:35], s55 offen offset:2048 lds
  s_waitcnt lgkmcnt(4)
  v_smfmac_f32_16x16x64_bf16 v[108:111], v[100:103], v[40:47], v99
  v_smfmac_f32_16x16x64_bf16 v[108:111], v[100:103], v[48:55], v99
  v_add_u32 v12, s60, v12
  v_add_u32 v13, s60, v13
  v_add_u32 v14, s60, v14
  v_add_u32 v15, s60, v15
  v_add_u32 v17, s60, v17
  v_add_u32 v5, s60, v5
  v_add_u32 v6, s60, v6
  s_waitcnt vmcnt(7)
  s_barrier
  ds_read_b128 v[56:59], v5 offset:0
  ds_read_b128 v[60:63], v6 offset:0
  ds_read_b128 v[64:67], v5 offset:2048
  ds_read_b128 v[68:71], v6 offset:2048
  ds_read_b64_tr_b16 v[40:41], v17 offset:0
  ds_read_b64_tr_b16 v[42:43], v17 offset:768
  ds_read_b64_tr_b16 v[44:45], v17 offset:3072
  ds_read_b64_tr_b16 v[46:47], v17 offset:3840
  ds_read_b64_tr_b16 v[48:49], v17 offset:6144
  ds_read_b64_tr_b16 v[50:51], v17 offset:6912
  ds_read_b64_tr_b16 v[52:53], v17 offset:9216
  ds_read_b64_tr_b16 v[54:55], v17 offset:9984
  s_add_u32 s61, s58, 7
  s_and_b32 s61, s61, 7
  s_add_u32 m0, s53, 57344
  s_lshl_b32 s55, s61, 7
  s_add_u32 s55, s55, s50
  buffer_load_dwordx4 v2, s[24:27], s55 offen offset:0 lds
  buffer_load_dwordx4 v18, s[24:27], s55 offen offset:1024 lds
  s_waitcnt lgkmcnt(8)
  v_smfmac_f32_16x16x64_bf16 v[116:119], v[8:11], v[56:63], v99
  ds_read_b128 v[208:211], v12
  buffer_load_dwordx4 v19, s[24:27], s55 offen offset:2048 lds
  v_mfma_f32_16x16x32_bf16 v[124:127], v[56:59], v[56:59], v[124:127]
  ds_read_b128 v[212:215], v13
  buffer_load_dwordx4 v20, s[24:27], s55 offen offset:3072 lds
  s_add_u32 s61, s58, 7
  s_and_b32 s61, s61, 7
  s_add_u32 m0, s54, 73728
  s_mul_i32 s55, s61, 196608
  s_add_u32 s55, s55, s51
  v_mfma_f32_16x16x32_bf16 v[124:127], v[60:63], v[60:63], v[124:127]
  v_smfmac_f32_16x16x64_bf16 v[120:123], v[8:11], v[64:71], v99
  buffer_load_dwordx4 v21, s[32:35], s55 offen offset:0 lds
  ds_read_b128 v[216:219], v14
  v_mfma_f32_16x16x32_bf16 v[104:107], v[64:67], v[64:67], v[104:107]
  buffer_load_dwordx4 v22, s[32:35], s55 offen offset:1024 lds
  ds_read_b128 v[220:223], v15
  v_mfma_f32_16x16x32_bf16 v[104:107], v[68:71], v[68:71], v[104:107]
  buffer_load_dwordx4 v23, s[32:35], s55 offen offset:2048 lds
  s_waitcnt lgkmcnt(4)
  v_smfmac_f32_16x16x64_bf16 v[108:111], v[100:103], v[40:47], v99
  v_smfmac_f32_16x16x64_bf16 v[108:111], v[100:103], v[48:55], v99
  v_add_u32 v12, s59, v12
  v_add_u32 v13, s59, v13
  v_add_u32 v14, s59, v14
  v_add_u32 v15, s59, v15
  v_add_u32 v17, s59, v17
  v_add_u32 v5, s59, v5
  v_add_u32 v6, s59, v6
  s_waitcnt vmcnt(7)
  s_barrier
  ds_read_b128 v[56:59], v5 offset:0
  ds_read_b128 v[60:63], v6 offset:0
  ds_read_b128 v[64:67], v5 offset:2048
  ds_read_b128 v[68:71], v6 offset:2048
  ds_read_b64_tr_b16 v[40:41], v17 offset:0
  ds_read_b64_tr_b16 v[42:43], v17 offset:768
  ds_read_b64_tr_b16 v[44:45], v17 offset:3072
  ds_read_b64_tr_b16 v[46:47], v17 offset:3840
  ds_read_b64_tr_b16 v[48:49], v17 offset:6144
  ds_read_b64_tr_b16 v[50:51], v17 offset:6912
  ds_read_b64_tr_b16 v[52:53], v17 offset:9216
  ds_read_b64_tr_b16 v[54:55], v17 offset:9984
  s_add_u32 s61, s58, 1
  s_and_b32 s61, s61, 7
  s_add_u32 m0, s54, 86016
  s_mul_i32 s55, s61, 176128
  s_add_u32 s55, s55, s52
  buffer_load_dwordx4 v24, s[40:43], s55 offen offset:0 lds
  buffer_load_dwordx4 v25, s[40:43], s55 offen offset:1024 lds
  s_waitcnt lgkmcnt(8)
  v_smfmac_f32_16x16x64_bf16 v[116:119], v[8:11], v[56:63], v99
  ds_read_b128 v[224:227], v12
  buffer_load_dwordx4 v26, s[40:43], s55 offen offset:2048 lds
  s_add_u32 s61, s58, 2
  s_and_b32 s61, s61, 7
  s_add_u32 m0, s54, 98304
  s_mul_i32 s55, s61, 176128
  s_add_u32 s55, s55, s52
  v_mfma_f32_16x16x32_bf16 v[124:127], v[56:59], v[56:59], v[124:127]
  ds_read_b128 v[228:231], v13
  buffer_load_dwordx4 v24, s[40:43], s55 offen offset:0 lds
  v_mfma_f32_16x16x32_bf16 v[124:127], v[60:63], v[60:63], v[124:127]
  v_smfmac_f32_16x16x64_bf16 v[120:123], v[8:11], v[64:71], v99
  buffer_load_dwordx4 v25, s[40:43], s55 offen offset:1024 lds
  ds_read_b128 v[232:235], v14
  v_mfma_f32_16x16x32_bf16 v[104:107], v[64:67], v[64:67], v[104:107]
  buffer_load_dwordx4 v26, s[40:43], s55 offen offset:2048 lds
  ds_read_b128 v[236:239], v15
  v_mfma_f32_16x16x32_bf16 v[104:107], v[68:71], v[68:71], v[104:107]
  s_waitcnt lgkmcnt(4)
  v_smfmac_f32_16x16x64_bf16 v[108:111], v[100:103], v[40:47], v99
  v_smfmac_f32_16x16x64_bf16 v[108:111], v[100:103], v[48:55], v99
  v_add_u32 v12, s59, v12
  v_add_u32 v13, s59, v13
  v_add_u32 v14, s59, v14
  v_add_u32 v15, s59, v15
  v_add_u32 v17, s59, v17
  v_add_u32 v5, s59, v5
  v_add_u32 v6, s59, v6
  s_waitcnt vmcnt(6)
  s_barrier
  ds_read_b128 v[56:59], v5 offset:0
  ds_read_b128 v[60:63], v6 offset:0
  ds_read_b128 v[64:67], v5 offset:2048
  ds_read_b128 v[68:71], v6 offset:2048
  ds_read_b64_tr_b16 v[40:41], v17 offset:0
  ds_read_b64_tr_b16 v[42:43], v17 offset:768
  ds_read_b64_tr_b16 v[44:45], v17 offset:3072
  ds_read_b64_tr_b16 v[46:47], v17 offset:3840
  ds_read_b64_tr_b16 v[48:49], v17 offset:6144
  ds_read_b64_tr_b16 v[50:51], v17 offset:6912
  ds_read_b64_tr_b16 v[52:53], v17 offset:9216
  ds_read_b64_tr_b16 v[54:55], v17 offset:9984
  s_add_u32 s61, s58, 3
  s_and_b32 s61, s61, 7
  s_add_u32 m0, s54, 114688
  s_mul_i32 s55, s61, 176128
  s_add_u32 s55, s55, s52
  buffer_load_dwordx4 v24, s[40:43], s55 offen offset:0 lds
  buffer_load_dwordx4 v25, s[40:43], s55 offen offset:1024 lds
  s_waitcnt lgkmcnt(8)
  v_smfmac_f32_16x16x64_bf16 v[116:119], v[8:11], v[56:63], v99
  ds_read_b128 v[240:243], v12
  buffer_load_dwordx4 v26, s[40:43], s55 offen offset:2048 lds
  s_add_u32 s61, s58, 4
  s_and_b32 s61, s61, 7
  s_add_u32 m0, s54, 126976
  s_mul_i32 s55, s61, 176128
  s_add_u32 s55, s55, s52
  v_mfma_f32_16x16x32_bf16 v[124:127], v[56:59], v[56:59], v[124:127]
  ds_read_b128 v[244:247], v13
  buffer_load_dwordx4 v24, s[40:43], s55 offen offset:0 lds
  v_mfma_f32_16x16x32_bf16 v[124:127], v[60:63], v[60:63], v[124:127]
  v_smfmac_f32_16x16x64_bf16 v[120:123], v[8:11], v[64:71], v99
  buffer_load_dwordx4 v25, s[40:43], s55 offen offset:1024 lds
  ds_read_b128 v[248:251], v14
  v_mfma_f32_16x16x32_bf16 v[104:107], v[64:67], v[64:67], v[104:107]
  buffer_load_dwordx4 v26, s[40:43], s55 offen offset:2048 lds
  ds_read_b128 v[252:255], v15
  v_mfma_f32_16x16x32_bf16 v[104:107], v[68:71], v[68:71], v[104:107]
  s_waitcnt lgkmcnt(4)
  v_smfmac_f32_16x16x64_bf16 v[108:111], v[100:103], v[40:47], v99
  v_smfmac_f32_16x16x64_bf16 v[108:111], v[100:103], v[48:55], v99
  s_waitcnt lgkmcnt(0)
  s_nop 1
  v_cndmask_b32 v32, v124, v125, s[66:67]
  v_cndmask_b32 v32, v32, v126, s[68:69]
  v_cndmask_b32 v32, v32, v127, s[44:45]
  v_cndmask_b32 v34, v104, v105, s[66:67]
  v_cndmask_b32 v34, v34, v106, s[68:69]
  v_cndmask_b32 v34, v34, v107, s[44:45]
  v_add_f32 v116, v116, v117
  v_mul_f32 v32, 0x3b000000, v32
  v_mul_f32 v116, 0x3b000000, v116
  v_add_f32 v120, v120, v121
  v_mul_f32 v34, 0x3b000000, v34
  v_mul_f32 v120, 0x3b000000, v120
  v_add_f32 v108, v108, v109
  v_add_f32 v110, v110, v111
  v_fma_f32 v32, -v116, v116, v32
  v_max_f32 v32, 0, v32
  v_add_f32 v33, 0x3727c5ac, v32
  v_fma_f32 v34, -v120, v120, v34
  v_max_f32 v34, 0, v34
  v_add_f32 v35, 0x3727c5ac, v34
  s_mov_b64 exec, 0xffff
  ds_write_b32 v29, v108
  ds_write_b32 v29, v110 offset:64
  s_mov_b64 exec, -1
  v_rsq_f32 v33, v33
  v_rsq_f32 v35, v35
  s_mov_b64 exec, s[46:47]
  ds_write_b32 v28, v116 offset:512
  ds_write_b32 v28, v33 offset:0
  ds_write_b32 v28, v120 offset:576
  ds_write_b32 v28, v35 offset:64
  s_mov_b64 exec, -1
  s_waitcnt lgkmcnt(0)
  s_barrier
  s_add_u32 s61, s58, 5
  s_and_b32 s61, s61, 7
  s_add_u32 m0, s54, 0
  s_mul_i32 s55, s61, 176128
  s_add_u32 s55, s55, s52
  buffer_load_dwordx4 v24, s[40:43], s55 offen offset:0 lds
  buffer_load_dwordx4 v25, s[40:43], s55 offen offset:1024 lds
  buffer_load_dwordx4 v26, s[40:43], s55 offen offset:2048 lds
  s_add_u32 s61, s58, 6
  s_and_b32 s61, s61, 7
  s_add_u32 m0, s54, 12288
  s_mul_i32 s55, s61, 176128
  s_add_u32 s55, s55, s52
  buffer_load_dwordx4 v24, s[40:43], s55 offen offset:0 lds
  buffer_load_dwordx4 v25, s[40:43], s55 offen offset:1024 lds
  buffer_load_dwordx4 v26, s[40:43], s55 offen offset:2048 lds
  s_add_u32 s61, s58, 7
  s_and_b32 s61, s61, 7
  s_add_u32 m0, s54, 28672
  s_mul_i32 s55, s61, 176128
  s_add_u32 s55, s55, s52
  buffer_load_dwordx4 v24, s[40:43], s55 offen offset:0 lds
  buffer_load_dwordx4 v25, s[40:43], s55 offen offset:1024 lds
  buffer_load_dwordx4 v26, s[40:43], s55 offen offset:2048 lds
  v_mul_f32 v117, v33, v33
  v_mul_f32 v117, v117, v32
  v_add_f32 v117, 0x3727c5ac, v117
  v_mul_f32 v121, v35, v35
  v_mul_f32 v121, v121, v34
  v_add_f32 v121, 0x3727c5ac, v121
  v_rsq_f32 v117, v117
  v_rsq_f32 v121, v121
  s_lshl_b32 s3, s37, 7
  v_lshlrev_b32 v27, 2, v3
  v_mul_f32 v118, v117, v33
  v_mul_f32 v119, v118, v116
  v_mul_f32 v122, v121, v35
  v_mul_f32 v123, v122, v120
  s_mov_b64 exec, s[46:47]
  ds_write_b32 v28, v118 offset:2560
  ds_write_b32 v28, v119 offset:3072
  ds_write_b32 v28, v122 offset:2624
  ds_write_b32 v28, v123 offset:3136
  s_mov_b64 exec, -1
  v_add_u32 v28, s3, v27
  v_add_u32 v28, 158208, v28
  s_waitcnt lgkmcnt(0)
  ds_read_b32 v38, v28
  ds_read_b32 v30, v28 offset:512
  v_lshlrev_b32 v34, 16, v31
  v_and_b32 v35, 0xffff0000, v31
  v_lshlrev_b32 v28, 3, v1
  v_add_u32 v28, 157696, v28
  v_cmp_gt_u32 vcc, 48, v1
  s_and_saveexec_b64 s[66:67], vcc
  ds_write_b64 v28, v[34:35]
  s_mov_b64 exec, s[66:67]
  s_mov_b32 s62, 0x00030003
  s_mov_b32 s63, 0x00030003
  s_add_u32 s3, s37, 0
  s_cmp_ge_u32 s3, 3
  s_cselect_b32 s55, 3, 0
  s_sub_u32 s3, s3, s55
  s_cmp_ge_u32 s3, 3
  s_cselect_b32 s55, 3, 0
  s_sub_u32 s3, s3, s55
  s_mov_b32 s57, s3
  s_add_u32 s3, s37, 1
  s_cmp_ge_u32 s3, 3
  s_cselect_b32 s55, 3, 0
  s_sub_u32 s3, s3, s55
  s_cmp_ge_u32 s3, 3
  s_cselect_b32 s55, 3, 0
  s_sub_u32 s3, s3, s55
  s_mov_b32 s59, s3
  s_add_u32 s3, s37, 2
  s_cmp_ge_u32 s3, 3
  s_cselect_b32 s55, 3, 0
  s_sub_u32 s3, s3, s55
  s_cmp_ge_u32 s3, 3
  s_cselect_b32 s55, 3, 0
  s_sub_u32 s3, s3, s55
  s_mov_b32 s60, s3
  v_mov_b32 v8, v100
  v_mov_b32 v9, v101
  v_mov_b32 v10, v102
  v_mov_b32 v11, v103
  v_mov_b32 v5, v99
  v_mov_b32 v124, 0
  v_mov_b32 v125, 0
  v_mov_b32 v126, 0
  v_mov_b32 v127, 0
  v_mov_b32 v64, 0
  v_mov_b32 v65, 0
  v_mov_b32 v66, 0
  v_mov_b32 v67, 0
  v_mov_b32 v68, 0
  v_mov_b32 v69, 0
  v_mov_b32 v70, 0
  v_mov_b32 v71, 0
  v_mov_b32 v72, 0
  v_mov_b32 v73, 0
  v_mov_b32 v74, 0
  v_mov_b32 v75, 0
  v_mov_b32 v76, 0
  v_mov_b32 v77, 0
  v_mov_b32 v78, 0
  v_mov_b32 v79, 0
  v_mov_b32 v80, 0
  v_mov_b32 v81, 0
  v_mov_b32 v82, 0
  v_mov_b32 v83, 0
  v_mov_b32 v84, 0
  v_mov_b32 v85, 0
  v_mov_b32 v86, 0
  v_mov_b32 v87, 0
  v_mov_b32 v88, 0
  v_mov_b32 v89, 0
  v_mov_b32 v90, 0
  v_mov_b32 v91, 0
  v_mov_b32 v92, 0
  v_mov_b32 v93, 0
  v_mov_b32 v94, 0
  v_mov_b32 v95, 0
  v_mov_b32 v96, 0
  v_mov_b32 v97, 0
  v_mov_b32 v98, 0
  v_mov_b32 v99, 0
  v_mov_b32 v100, 0
  v_mov_b32 v101, 0
  v_mov_b32 v102, 0
  v_mov_b32 v103, 0
  v_mov_b32 v104, 0
  v_mov_b32 v105, 0
  v_mov_b32 v106, 0
  v_mov_b32 v107, 0
  v_mov_b32 v108, 0
  v_mov_b32 v109, 0
  v_mov_b32 v110, 0
  v_mov_b32 v111, 0
  s_lshl_b32 s3, s57, 6
  v_add_u32 v12, s3, v16
  v_add_u32 v13, 86016, v12
  v_add_u32 v14, 126976, v12
  s_mov_b32 s66, 0xbdd2d3e8
  v_mov_b32 v32, 0xc0135761
  v_lshlrev_b32 v23, 4, v4
  v_lshlrev_b32 v15, 4, v1
  s_lshl_b32 s53, s38, 2
  s_add_u32 s53, s53, s37
  s_mul_i32 s53, s53, 86
  s_add_u32 s54, s48, s57
  s_lshl_b32 s54, s54, 1
  s_add_u32 s54, s54, s53
  s_lshl_b32 s54, s54, 10
  s_add_u32 s54, s54, 9437184
  s_cmp_ge_u32 s57, s49
  s_cselect_b32 s67, 0x7ff00000, s54
  s_lshl_b32 s3, s57, 7
  v_add_u32 v33, s3, v23
  v_add_u32 v33, 157184, v33
  s_add_u32 s54, s48, s59
  s_lshl_b32 s54, s54, 1
  s_add_u32 s54, s54, s53
  s_lshl_b32 s54, s54, 10
  s_add_u32 s54, s54, 9437184
  s_cmp_ge_u32 s59, s49
  s_cselect_b32 s68, 0x7ff00000, s54
  s_lshl_b32 s3, s59, 7
  v_add_u32 v34, s3, v23
  v_add_u32 v34, 157184, v34
  s_add_u32 s54, s48, s60
  s_lshl_b32 s54, s54, 1
  s_add_u32 s54, s54, s53
  s_lshl_b32 s54, s54, 10
  s_add_u32 s54, s54, 9437184
  s_cmp_ge_u32 s60, s49
  s_cselect_b32 s69, 0x7ff00000, s54
  s_lshl_b32 s3, s60, 7
  v_add_u32 v35, s3, v23
  v_add_u32 v35, 157184, v35
  v_lshlrev_b32 v29, 2, v1
  s_lshl_b32 s55, s57, 7
  s_add_u32 s55, s55, 157184
  v_add_u32 v29, s55, v29
  v_mov_b32 v17, 159756
  v_mov_b32 v7, 1
  s_waitcnt vmcnt(18)
  s_waitcnt lgkmcnt(0)
  s_mov_b64 exec, 1
  ds_add_u32 v17, v7
  s_mov_b64 exec, -1
GB_2:
  ds_read_b32 v6, v17
  s_waitcnt lgkmcnt(0)
  v_readfirstlane_b32 s3, v6
  s_nop 0
  s_cmp_ge_u32 s3, 4
  s_cbranch_scc0 GB_2
  ds_read_b64_tr_b16 v[40:41], v14 offset:16384
  ds_read_b64_tr_b16 v[42:43], v14 offset:17152
  ds_read_b64_tr_b16 v[44:45], v14 offset:19456
  ds_read_b64_tr_b16 v[46:47], v14 offset:20224
  ds_read_b64_tr_b16 v[48:49], v14 offset:22528
  ds_read_b64_tr_b16 v[50:51], v14 offset:23296
  s_waitcnt lgkmcnt(4)
  v_mfma_f32_32x32x16_bf16 v[64:79], v[40:43], v[128:131], v[64:79]
  ds_read_b64_tr_b16 v[52:53], v14 offset:25600
  ds_read_b64_tr_b16 v[54:55], v14 offset:26368
  s_waitcnt lgkmcnt(4)
  v_mfma_f32_32x32x16_bf16 v[64:79], v[44:47], v[132:135], v[64:79]
  v_smfmac_f32_16x16x64_bf16 v[124:127], v[8:11], v[40:47], v5
  ds_read_b64_tr_b16 v[40:41], v13 offset:0
  ds_read_b64_tr_b16 v[42:43], v13 offset:768
  s_waitcnt lgkmcnt(4)
  v_mfma_f32_32x32x16_bf16 v[64:79], v[48:51], v[136:139], v[64:79]
  ds_read_b64_tr_b16 v[44:45], v13 offset:3072
  ds_read_b64_tr_b16 v[46:47], v13 offset:3840
  s_waitcnt lgkmcnt(4)
  v_mfma_f32_32x32x16_bf16 v[64:79], v[52:55], v[140:143], v[64:79]
  v_smfmac_f32_16x16x64_bf16 v[124:127], v[8:11], v[48:55], v5
  ds_read_b64_tr_b16 v[48:49], v13 offset:6144
  ds_read_b64_tr_b16 v[50:51], v13 offset:6912
  s_waitcnt vmcnt(9)
  s_mov_b64 exec, 1
  ds_add_u32 v17, v7
  s_mov_b64 exec, -1
  s_waitcnt lgkmcnt(5)
  v_mfma_f32_32x32x16_bf16 v[64:79], v[40:43], v[144:147], v[64:79]
  ds_read_b64_tr_b16 v[52:53], v13 offset:9216
  ds_read_b64_tr_b16 v[54:55], v13 offset:9984
  s_waitcnt lgkmcnt(5)
  v_mfma_f32_32x32x16_bf16 v[64:79], v[44:47], v[148:151], v[64:79]
  v_smfmac_f32_16x16x64_bf16 v[124:127], v[8:11], v[40:47], v5
GB_3:
  ds_read_b32 v6, v17
  s_waitcnt lgkmcnt(0)
  v_readfirstlane_b32 s3, v6
  s_nop 0
  s_cmp_ge_u32 s3, 8
  s_cbranch_scc0 GB_3
  ds_read_b64_tr_b16 v[40:41], v13 offset:12288
  ds_read_b64_tr_b16 v[42:43], v13 offset:13056
  v_mfma_f32_32x32x16_bf16 v[64:79], v[48:51], v[152:155], v[64:79]
  ds_read_b64_tr_b16 v[44:45], v13 offset:15360
  ds_read_b64_tr_b16 v[46:47], v13 offset:16128
  v_mfma_f32_32x32x16_bf16 v[64:79], v[52:55], v[156:159], v[64:79]
  v_smfmac_f32_16x16x64_bf16 v[124:127], v[8:11], v[48:55], v5
  ds_read_b64_tr_b16 v[48:49], v13 offset:18432
  ds_read_b64_tr_b16 v[50:51], v13 offset:19200
  s_waitcnt lgkmcnt(4)
  v_mfma_f32_32x32x16_bf16 v[64:79], v[40:43], v[160:163], v[64:79]
  ds_read_b64_tr_b16 v[52:53], v13 offset:21504
  ds_read_b64_tr_b16 v[54:55], v13 offset:22272
  s_waitcnt lgkmcnt(4)
  v_mfma_f32_32x32x16_bf16 v[64:79], v[44:47], v[164:167], v[64:79]
  v_smfmac_f32_16x16x64_bf16 v[124:127], v[8:11], v[40:47], v5
  ds_read_b64_tr_b16 v[40:41], v13 offset:28672
  ds_read_b64_tr_b16 v[42:43], v13 offset:29440
  s_waitcnt lgkmcnt(4)
  v_mfma_f32_32x32x16_bf16 v[64:79], v[48:51], v[168:171], v[64:79]
  ds_read_b64_tr_b16 v[44:45], v13 offset:31744
  ds_read_b64_tr_b16 v[46:47], v13 offset:32512
  s_waitcnt lgkmcnt(4)
  v_mfma_f32_32x32x16_bf16 v[64:79], v[52:55], v[172:175], v[64:79]
  v_smfmac_f32_16x16x64_bf16 v[124:127], v[8:11], v[48:55], v5
  ds_read_b64_tr_b16 v[48:49], v13 offset:34816
  ds_read_b64_tr_b16 v[50:51], v13 offset:35584
  s_waitcnt lgkmcnt(4)
  v_mfma_f32_32x32x16_bf16 v[64:79], v[40:43], v[176:179], v[64:79]
  ds_read_b64_tr_b16 v[52:53], v13 offset:37888
  ds_read_b64_tr_b16 v[54:55], v13 offset:38656
  s_waitcnt lgkmcnt(4)
  v_mfma_f32_32x32x16_bf16 v[64:79], v[44:47], v[180:183], v[64:79]
  v_smfmac_f32_16x16x64_bf16 v[124:127], v[8:11], v[40:47], v5
  ds_read_b64_tr_b16 v[40:41], v14 offset:0
  ds_read_b64_tr_b16 v[42:43], v14 offset:768
  s_waitcnt lgkmcnt(4)
  v_mfma_f32_32x32x16_bf16 v[64:79], v[48:51], v[184:187], v[64:79]
  ds_read_b64_tr_b16 v[44:45], v14 offset:3072
  ds_read_b64_tr_b16 v[46:47], v14 offset:3840
  s_waitcnt lgkmcnt(4)
  v_mfma_f32_32x32x16_bf16 v[64:79], v[52:55], v[188:191], v[64:79]
  v_smfmac_f32_16x16x64_bf16 v[124:127], v[8:11], v[48:55], v5
  ds_read_b64_tr_b16 v[48:49], v14 offset:6144
  ds_read_b64_tr_b16 v[50:51], v14 offset:6912
  s_waitcnt vmcnt(0)
  s_mov_b64 exec, 1
  ds_add_u32 v17, v7
  s_mov_b64 exec, -1
  s_waitcnt lgkmcnt(5)
  v_mfma_f32_32x32x16_bf16 v[64:79], v[40:43], v[192:195], v[64:79]
  ds_read_b64_tr_b16 v[52:53], v14 offset:9216
  ds_read_b64_tr_b16 v[54:55], v14 offset:9984
  s_waitcnt lgkmcnt(5)
  v_mfma_f32_32x32x16_bf16 v[64:79], v[44:47], v[196:199], v[64:79]
  v_smfmac_f32_16x16x64_bf16 v[124:127], v[8:11], v[40:47], v5
GB_4:
  ds_read_b32 v6, v17
  s_waitcnt lgkmcnt(0)
  v_readfirstlane_b32 s3, v6
  s_nop 0
  s_cmp_ge_u32 s3, 12
  s_cbranch_scc0 GB_4
  ds_read_b64_tr_b16 v[40:41], v12 offset:0
  ds_read_b64_tr_b16 v[42:43], v12 offset:768
  v_mfma_f32_32x32x16_bf16 v[64:79], v[48:51], v[200:203], v[64:79]
  ds_read_b64_tr_b16 v[44:45], v12 offset:3072
  ds_read_b64_tr_b16 v[46:47], v12 offset:3840
  v_mfma_f32_32x32x16_bf16 v[64:79], v[52:55], v[204:207], v[64:79]
  v_smfmac_f32_16x16x64_bf16 v[124:127], v[8:11], v[48:55], v5
  ds_read_b64_tr_b16 v[48:49], v12 offset:6144
  ds_read_b64_tr_b16 v[50:51], v12 offset:6912
  s_waitcnt lgkmcnt(4)
  v_mfma_f32_32x32x16_bf16 v[64:79], v[40:43], v[208:211], v[64:79]
  ds_read_b64_tr_b16 v[52:53], v12 offset:9216
  ds_read_b64_tr_b16 v[54:55], v12 offset:9984
  s_waitcnt lgkmcnt(4)
  v_mfma_f32_32x32x16_bf16 v[64:79], v[44:47], v[212:215], v[64:79]
  v_smfmac_f32_16x16x64_bf16 v[124:127], v[8:11], v[40:47], v5
  ds_read_b64_tr_b16 v[40:41], v12 offset:12288
  ds_read_b64_tr_b16 v[42:43], v12 offset:13056
  s_waitcnt lgkmcnt(4)
  v_mfma_f32_32x32x16_bf16 v[64:79], v[48:51], v[216:219], v[64:79]
  ds_read_b64_tr_b16 v[44:45], v12 offset:15360
  ds_read_b64_tr_b16 v[46:47], v12 offset:16128
  s_waitcnt lgkmcnt(4)
  v_mfma_f32_32x32x16_bf16 v[64:79], v[52:55], v[220:223], v[64:79]
  v_smfmac_f32_16x16x64_bf16 v[124:127], v[8:11], v[48:55], v5
  ds_read_b64_tr_b16 v[48:49], v12 offset:18432
  ds_read_b64_tr_b16 v[50:51], v12 offset:19200
  s_waitcnt lgkmcnt(4)
  v_mfma_f32_32x32x16_bf16 v[64:79], v[40:43], v[224:227], v[64:79]
  ds_read_b64_tr_b16 v[52:53], v12 offset:21504
  ds_read_b64_tr_b16 v[54:55], v12 offset:22272
  s_waitcnt lgkmcnt(4)
  v_mfma_f32_32x32x16_bf16 v[64:79], v[44:47], v[228:231], v[64:79]
  v_smfmac_f32_16x16x64_bf16 v[124:127], v[8:11], v[40:47], v5
  ds_read_b64_tr_b16 v[40:41], v12 offset:28672
  ds_read_b64_tr_b16 v[42:43], v12 offset:29440
  s_waitcnt lgkmcnt(4)
  v_mfma_f32_32x32x16_bf16 v[64:79], v[48:51], v[232:235], v[64:79]
  ds_read_b64_tr_b16 v[44:45], v12 offset:31744
  ds_read_b64_tr_b16 v[46:47], v12 offset:32512
  s_waitcnt lgkmcnt(4)
  v_mfma_f32_32x32x16_bf16 v[64:79], v[52:55], v[236:239], v[64:79]
  v_smfmac_f32_16x16x64_bf16 v[124:127], v[8:11], v[48:55], v5
  ds_read_b64_tr_b16 v[48:49], v12 offset:34816
  ds_read_b64_tr_b16 v[50:51], v12 offset:35584
  s_waitcnt lgkmcnt(4)
  v_mfma_f32_32x32x16_bf16 v[64:79], v[40:43], v[240:243], v[64:79]
  ds_read_b64_tr_b16 v[52:53], v12 offset:37888
  ds_read_b64_tr_b16 v[54:55], v12 offset:38656
  s_waitcnt lgkmcnt(4)
  v_mfma_f32_32x32x16_bf16 v[64:79], v[44:47], v[244:247], v[64:79]
  v_smfmac_f32_16x16x64_bf16 v[124:127], v[8:11], v[40:47], v5
  s_sub_u32 s3, s59, s57
  s_lshl_b32 s3, s3, 6
  v_add_u32 v12, s3, v12
  v_add_u32 v13, s3, v13
  v_add_u32 v14, s3, v14
  ds_read_b64_tr_b16 v[40:41], v14 offset:16384
  ds_read_b64_tr_b16 v[42:43], v14 offset:17152
  s_waitcnt lgkmcnt(4)
  v_mfma_f32_32x32x16_bf16 v[64:79], v[48:51], v[248:251], v[64:79]
  ds_read_b64_tr_b16 v[44:45], v14 offset:19456
  ds_read_b64_tr_b16 v[46:47], v14 offset:20224
  s_waitcnt lgkmcnt(4)
  v_mfma_f32_32x32x16_bf16 v[64:79], v[52:55], v[252:255], v[64:79]
  v_smfmac_f32_16x16x64_bf16 v[124:127], v[8:11], v[48:55], v5
  ds_read_b64_tr_b16 v[48:49], v14 offset:22528
  ds_read_b64_tr_b16 v[50:51], v14 offset:23296
  s_waitcnt lgkmcnt(4)
  v_mfma_f32_32x32x16_bf16 v[80:95], v[40:43], v[128:131], v[80:95]
  ds_read_b64_tr_b16 v[52:53], v14 offset:25600
  ds_read_b64_tr_b16 v[54:55], v14 offset:26368
  s_waitcnt lgkmcnt(4)
  v_mfma_f32_32x32x16_bf16 v[80:95], v[44:47], v[132:135], v[80:95]
  ds_read_b64_tr_b16 v[40:41], v13 offset:0
  ds_read_b64_tr_b16 v[42:43], v13 offset:768
  s_nop 3
  v_add_f32 v124, v124, v125
  v_add_f32 v126, v126, v127
  s_mov_b64 exec, 0xffff
  ds_write_b32 v29, v124
  ds_write_b32 v29, v126 offset:64
  s_mov_b64 exec, -1
  s_waitcnt lgkmcnt(0)
  s_mov_b64 exec, 1
  ds_add_u32 v17, v7
  s_mov_b64 exec, -1
  ds_read_b128 v[112:115], v33 offset:0
  ds_read_b128 v[120:123], v33 offset:512
  ds_read_b128 v[116:119], v33 offset:32
  ds_read_b128 v[124:127], v33 offset:544
  v_mfma_f32_32x32x16_bf16 v[80:95], v[48:51], v[136:139], v[80:95]
  ds_read_b64_tr_b16 v[44:45], v13 offset:3072
  ds_read_b64_tr_b16 v[46:47], v13 offset:3840
  ds_read_b128 v[56:59], v33 offset:64
  ds_read_b128 v[18:21], v33 offset:576
  ds_read_b128 v[60:63], v33 offset:96
  ds_read_b128 v[22:25], v33 offset:608
  v_mfma_f32_32x32x16_bf16 v[80:95], v[52:55], v[140:143], v[80:95]
  ds_read_b64_tr_b16 v[48:49], v13 offset:6144
  ds_read_b64_tr_b16 v[50:51], v13 offset:6912
  s_waitcnt lgkmcnt(8)
  v_fma_f32 v120, -v112, v30, v120
  v_fma_f32 v121, -v113, v30, v121
  v_fma_f32 v122, -v114, v30, v122
  v_fma_f32 v123, -v115, v30, v123
  v_mfma_f32_32x32x16_bf16 v[80:95], v[40:43], v[144:147], v[80:95]
  ds_read_b64_tr_b16 v[52:53], v13 offset:9216
  ds_read_b64_tr_b16 v[54:55], v13 offset:9984
  v_fma_f32 v124, -v116, v30, v124
  v_fma_f32 v125, -v117, v30, v125
  v_fma_f32 v126, -v118, v30, v126
  v_fma_f32 v127, -v119, v30, v127
  s_waitcnt lgkmcnt(8)
  v_mfma_f32_32x32x16_bf16 v[80:95], v[44:47], v[148:151], v[80:95]
  ds_read_b64_tr_b16 v[40:41], v13 offset:12288
  ds_read_b64_tr_b16 v[42:43], v13 offset:13056
  v_fma_f32 v64, v64, v38, v120
  v_fma_f32 v65, v65, v38, v121
  v_fma_f32 v66, v66, v38, v122
  v_fma_f32 v67, v67, v38, v123
  s_waitcnt lgkmcnt(4)
  v_mfma_f32_32x32x16_bf16 v[80:95], v[48:51], v[152:155], v[80:95]
  ds_read_b64_tr_b16 v[44:45], v13 offset:15360
  ds_read_b64_tr_b16 v[46:47], v13 offset:16128
  v_fma_f32 v68, v68, v38, v124
  v_fma_f32 v69, v69, v38, v125
  v_fma_f32 v70, v70, v38, v126
  v_fma_f32 v71, v71, v38, v127
  s_waitcnt lgkmcnt(4)
  v_mfma_f32_32x32x16_bf16 v[80:95], v[52:55], v[156:159], v[80:95]
  ds_read_b64_tr_b16 v[48:49], v13 offset:18432
  ds_read_b64_tr_b16 v[50:51], v13 offset:19200
  v_mul_f32 v112, v64, v64
  v_mul_f32 v113, v65, v65
  v_mul_f32 v114, v66, v66
  v_mul_f32 v115, v67, v67
  s_waitcnt lgkmcnt(4)
  v_mfma_f32_32x32x16_bf16 v[80:95], v[40:43], v[160:163], v[80:95]
  ds_read_b64_tr_b16 v[52:53], v13 offset:21504
  ds_read_b64_tr_b16 v[54:55], v13 offset:22272
  v_mul_f32 v116, v68, v68
  v_mul_f32 v117, v69, v69
  v_mul_f32 v118, v70, v70
  v_mul_f32 v119, v71, v71
  s_waitcnt lgkmcnt(4)
  v_mfma_f32_32x32x16_bf16 v[80:95], v[44:47], v[164:167], v[80:95]
  ds_read_b64_tr_b16 v[40:41], v13 offset:28672
  ds_read_b64_tr_b16 v[42:43], v13 offset:29440
  v_fma_f32 v112, v112, s66, v32
  v_fma_f32 v113, v113, s66, v32
  v_fma_f32 v114, v114, s66, v32
  v_fma_f32 v115, v115, s66, v32
  s_waitcnt lgkmcnt(4)
  v_mfma_f32_32x32x16_bf16 v[80:95], v[48:51], v[168:171], v[80:95]
  ds_read_b64_tr_b16 v[44:45], v13 offset:31744
  ds_read_b64_tr_b16 v[46:47], v13 offset:32512
  v_fma_f32 v116, v116, s66, v32
  v_fma_f32 v117, v117, s66, v32
  v_fma_f32 v118, v118, s66, v32
  v_fma_f32 v119, v119, s66, v32
  s_waitcnt lgkmcnt(4)
  v_mfma_f32_32x32x16_bf16 v[80:95], v[52:55], v[172:175], v[80:95]
  ds_read_b64_tr_b16 v[48:49], v13 offset:34816
  ds_read_b64_tr_b16 v[50:51], v13 offset:35584
  v_mul_f32 v112, v112, v64
  v_mul_f32 v113, v113, v65
  v_mul_f32 v114, v114, v66
  v_mul_f32 v115, v115, v67
  s_waitcnt lgkmcnt(4)
  v_mfma_f32_32x32x16_bf16 v[80:95], v[40:43], v[176:179], v[80:95]
  ds_read_b64_tr_b16 v[52:53], v13 offset:37888
  ds_read_b64_tr_b16 v[54:55], v13 offset:38656
  v_mul_f32 v116, v116, v68
  v_mul_f32 v117, v117, v69
  v_mul_f32 v118, v118, v70
  v_mul_f32 v119, v119, v71
  s_waitcnt lgkmcnt(4)
  v_mfma_f32_32x32x16_bf16 v[80:95], v[44:47], v[180:183], v[80:95]
  ds_read_b64_tr_b16 v[40:41], v14 offset:0
  ds_read_b64_tr_b16 v[42:43], v14 offset:768
  v_exp_f32 v112, v112
  v_exp_f32 v113, v113
  s_waitcnt lgkmcnt(4)
  v_mfma_f32_32x32x16_bf16 v[80:95], v[48:51], v[184:187], v[80:95]
  ds_read_b64_tr_b16 v[44:45], v14 offset:3072
  ds_read_b64_tr_b16 v[46:47], v14 offset:3840
  v_exp_f32 v114, v114
  v_exp_f32 v115, v115
  s_waitcnt lgkmcnt(4)
  v_mfma_f32_32x32x16_bf16 v[80:95], v[52:55], v[188:191], v[80:95]
  ds_read_b64_tr_b16 v[48:49], v14 offset:6144
  ds_read_b64_tr_b16 v[50:51], v14 offset:6912
  v_exp_f32 v116, v116
  v_exp_f32 v117, v117
  s_waitcnt lgkmcnt(4)
  v_mfma_f32_32x32x16_bf16 v[80:95], v[40:43], v[192:195], v[80:95]
  ds_read_b64_tr_b16 v[52:53], v14 offset:9216
  ds_read_b64_tr_b16 v[54:55], v14 offset:9984
  v_exp_f32 v118, v118
  v_exp_f32 v119, v119
  s_waitcnt lgkmcnt(4)
  v_mfma_f32_32x32x16_bf16 v[80:95], v[44:47], v[196:199], v[80:95]
  ds_read_b64_tr_b16 v[40:41], v12 offset:0
  ds_read_b64_tr_b16 v[42:43], v12 offset:768
  v_add_f32 v112, 1.0, v112
  v_add_f32 v113, 1.0, v113
  v_add_f32 v114, 1.0, v114
  v_add_f32 v115, 1.0, v115
  s_waitcnt lgkmcnt(4)
  v_mfma_f32_32x32x16_bf16 v[80:95], v[48:51], v[200:203], v[80:95]
  ds_read_b64_tr_b16 v[44:45], v12 offset:3072
  ds_read_b64_tr_b16 v[46:47], v12 offset:3840
  v_add_f32 v116, 1.0, v116
  v_add_f32 v117, 1.0, v117
  v_add_f32 v118, 1.0, v118
  v_add_f32 v119, 1.0, v119
  s_waitcnt lgkmcnt(4)
  v_mfma_f32_32x32x16_bf16 v[80:95], v[52:55], v[204:207], v[80:95]
  ds_read_b64_tr_b16 v[48:49], v12 offset:6144
  ds_read_b64_tr_b16 v[50:51], v12 offset:6912
  v_rcp_f32 v112, v112
  v_rcp_f32 v113, v113
  s_waitcnt lgkmcnt(4)
  v_mfma_f32_32x32x16_bf16 v[80:95], v[40:43], v[208:211], v[80:95]
  ds_read_b64_tr_b16 v[52:53], v12 offset:9216
  ds_read_b64_tr_b16 v[54:55], v12 offset:9984
  v_rcp_f32 v114, v114
  v_rcp_f32 v115, v115
  s_waitcnt lgkmcnt(4)
  v_mfma_f32_32x32x16_bf16 v[80:95], v[44:47], v[212:215], v[80:95]
  ds_read_b64_tr_b16 v[40:41], v12 offset:12288
  ds_read_b64_tr_b16 v[42:43], v12 offset:13056
  v_rcp_f32 v116, v116
  v_rcp_f32 v117, v117
  s_waitcnt lgkmcnt(4)
  v_mfma_f32_32x32x16_bf16 v[80:95], v[48:51], v[216:219], v[80:95]
  ds_read_b64_tr_b16 v[44:45], v12 offset:15360
  ds_read_b64_tr_b16 v[46:47], v12 offset:16128
  v_rcp_f32 v118, v118
  v_rcp_f32 v119, v119
  s_waitcnt lgkmcnt(4)
  v_mfma_f32_32x32x16_bf16 v[80:95], v[52:55], v[220:223], v[80:95]
  ds_read_b64_tr_b16 v[48:49], v12 offset:18432
  ds_read_b64_tr_b16 v[50:51], v12 offset:19200
  v_mul_f32 v64, v64, v112
  v_mul_f32 v65, v65, v113
  v_mul_f32 v66, v66, v114
  v_mul_f32 v67, v67, v115
  s_waitcnt lgkmcnt(4)
  v_mfma_f32_32x32x16_bf16 v[80:95], v[40:43], v[224:227], v[80:95]
  ds_read_b64_tr_b16 v[52:53], v12 offset:21504
  ds_read_b64_tr_b16 v[54:55], v12 offset:22272
  v_mul_f32 v68, v68, v116
  v_mul_f32 v69, v69, v117
  v_mul_f32 v70, v70, v118
  v_mul_f32 v71, v71, v119
  s_waitcnt lgkmcnt(4)
  v_mfma_f32_32x32x16_bf16 v[80:95], v[44:47], v[228:231], v[80:95]
  ds_read_b64_tr_b16 v[40:41], v12 offset:28672
  ds_read_b64_tr_b16 v[42:43], v12 offset:29440
  v_cvt_pk_bf16_f32 v120, v64, v65
  v_cvt_pk_bf16_f32 v121, v66, v67
  v_cvt_pk_bf16_f32 v122, v68, v69
  v_cvt_pk_bf16_f32 v123, v70, v71
  s_waitcnt lgkmcnt(4)
  v_mfma_f32_32x32x16_bf16 v[80:95], v[48:51], v[232:235], v[80:95]
  ds_read_b64_tr_b16 v[44:45], v12 offset:31744
  ds_read_b64_tr_b16 v[46:47], v12 offset:32512
  buffer_store_dwordx4 v[120:123], v15, s[28:31], s67 offen offset:0 sc1
  s_nop 1
GB_5:
  ds_read_b32 v6, v17
  s_waitcnt lgkmcnt(0)
  v_readfirstlane_b32 s3, v6
  s_nop 0
  s_cmp_ge_u32 s3, 16
  s_cbranch_scc0 GB_5
  ds_read_b128 v[112:115], v34 offset:0
  ds_read_b128 v[120:123], v34 offset:512
  ds_read_b128 v[116:119], v34 offset:32
  v_mfma_f32_32x32x16_bf16 v[80:95], v[52:55], v[236:239], v[80:95]
  ds_read_b64_tr_b16 v[48:49], v12 offset:34816
  ds_read_b64_tr_b16 v[50:51], v12 offset:35584
  ds_read_b128 v[124:127], v34 offset:544
  v_fma_f32 v18, -v56, v30, v18
  v_fma_f32 v19, -v57, v30, v19
  v_fma_f32 v20, -v58, v30, v20
  v_mfma_f32_32x32x16_bf16 v[80:95], v[40:43], v[240:243], v[80:95]
  ds_read_b64_tr_b16 v[52:53], v12 offset:37888
  ds_read_b64_tr_b16 v[54:55], v12 offset:38656
  v_fma_f32 v21, -v59, v30, v21
  v_fma_f32 v22, -v60, v30, v22
  v_fma_f32 v23, -v61, v30, v23
  v_fma_f32 v24, -v62, v30, v24
  v_mfma_f32_32x32x16_bf16 v[80:95], v[44:47], v[244:247], v[80:95]
  s_sub_u32 s3, s60, s59
  s_lshl_b32 s3, s3, 6
  v_add_u32 v12, s3, v12
  v_add_u32 v13, s3, v13
  v_add_u32 v14, s3, v14
  ds_read_b64_tr_b16 v[40:41], v14 offset:16384
  ds_read_b64_tr_b16 v[42:43], v14 offset:17152
  v_fma_f32 v25, -v63, v30, v25
  v_fma_f32 v72, v72, v38, v18
  v_fma_f32 v73, v73, v38, v19
  v_fma_f32 v74, v74, v38, v20
  s_waitcnt lgkmcnt(5)
  v_mfma_f32_32x32x16_bf16 v[80:95], v[48:51], v[248:251], v[80:95]
  ds_read_b64_tr_b16 v[44:45], v14 offset:19456
  ds_read_b64_tr_b16 v[46:47], v14 offset:20224
  v_fma_f32 v75, v75, v38, v21
  v_fma_f32 v76, v76, v38, v22
  v_fma_f32 v77, v77, v38, v23
  v_fma_f32 v78, v78, v38, v24
  s_waitcnt lgkmcnt(4)
  v_mfma_f32_32x32x16_bf16 v[80:95], v[52:55], v[252:255], v[80:95]
  ds_read_b64_tr_b16 v[48:49], v14 offset:22528
  ds_read_b64_tr_b16 v[50:51], v14 offset:23296
  v_fma_f32 v79, v79, v38, v25
  v_mul_f32 v56, v72, v72
  v_mul_f32 v57, v73, v73
  v_mul_f32 v58, v74, v74
  s_waitcnt lgkmcnt(4)
  v_mfma_f32_32x32x16_bf16 v[96:111], v[40:43], v[128:131], v[96:111]
  ds_read_b64_tr_b16 v[52:53], v14 offset:25600
  ds_read_b64_tr_b16 v[54:55], v14 offset:26368
  v_mul_f32 v59, v75, v75
  v_mul_f32 v60, v76, v76
  v_mul_f32 v61, v77, v77
  v_mul_f32 v62, v78, v78
  s_waitcnt lgkmcnt(4)
  v_mfma_f32_32x32x16_bf16 v[96:111], v[44:47], v[132:135], v[96:111]
  ds_read_b64_tr_b16 v[40:41], v13 offset:0
  ds_read_b64_tr_b16 v[42:43], v13 offset:768
  v_mul_f32 v63, v79, v79
  v_fma_f32 v56, v56, s66, v32
  v_fma_f32 v57, v57, s66, v32
  v_fma_f32 v58, v58, s66, v32
  s_waitcnt lgkmcnt(4)
  v_mfma_f32_32x32x16_bf16 v[96:111], v[48:51], v[136:139], v[96:111]
  ds_read_b64_tr_b16 v[44:45], v13 offset:3072
  ds_read_b64_tr_b16 v[46:47], v13 offset:3840
  v_fma_f32 v59, v59, s66, v32
  v_fma_f32 v60, v60, s66, v32
  v_fma_f32 v61, v61, s66, v32
  v_fma_f32 v62, v62, s66, v32
  s_waitcnt lgkmcnt(4)
  v_mfma_f32_32x32x16_bf16 v[96:111], v[52:55], v[140:143], v[96:111]
  ds_read_b64_tr_b16 v[48:49], v13 offset:6144
  ds_read_b64_tr_b16 v[50:51], v13 offset:6912
  v_fma_f32 v63, v63, s66, v32
  v_mul_f32 v56, v56, v72
  v_mul_f32 v57, v57, v73
  v_mul_f32 v58, v58, v74
  s_waitcnt lgkmcnt(4)
  v_mfma_f32_32x32x16_bf16 v[96:111], v[40:43], v[144:147], v[96:111]
  ds_read_b64_tr_b16 v[52:53], v13 offset:9216
  ds_read_b64_tr_b16 v[54:55], v13 offset:9984
  v_mul_f32 v59, v59, v75
  v_mul_f32 v60, v60, v76
  v_mul_f32 v61, v61, v77
  v_mul_f32 v62, v62, v78
  s_waitcnt lgkmcnt(4)
  v_mfma_f32_32x32x16_bf16 v[96:111], v[44:47], v[148:151], v[96:111]
  ds_read_b64_tr_b16 v[40:41], v13 offset:12288
  ds_read_b64_tr_b16 v[42:43], v13 offset:13056
  v_mul_f32 v63, v63, v79
  v_exp_f32 v56, v56
  v_exp_f32 v57, v57
  s_waitcnt lgkmcnt(4)
  v_mfma_f32_32x32x16_bf16 v[96:111], v[48:51], v[152:155], v[96:111]
  ds_read_b64_tr_b16 v[44:45], v13 offset:15360
  ds_read_b64_tr_b16 v[46:47], v13 offset:16128
  v_exp_f32 v58, v58
  v_exp_f32 v59, v59
  s_waitcnt lgkmcnt(4)
  v_mfma_f32_32x32x16_bf16 v[96:111], v[52:55], v[156:159], v[96:111]
  ds_read_b64_tr_b16 v[48:49], v13 offset:18432
  ds_read_b64_tr_b16 v[50:51], v13 offset:19200
  v_exp_f32 v60, v60
  v_exp_f32 v61, v61
  s_waitcnt lgkmcnt(4)
  v_mfma_f32_32x32x16_bf16 v[96:111], v[40:43], v[160:163], v[96:111]
  ds_read_b64_tr_b16 v[52:53], v13 offset:21504
  ds_read_b64_tr_b16 v[54:55], v13 offset:22272
  v_exp_f32 v62, v62
  v_exp_f32 v63, v63
  s_waitcnt lgkmcnt(4)
  v_mfma_f32_32x32x16_bf16 v[96:111], v[44:47], v[164:167], v[96:111]
  ds_read_b64_tr_b16 v[40:41], v13 offset:28672
  ds_read_b64_tr_b16 v[42:43], v13 offset:29440
  v_add_f32 v56, 1.0, v56
  v_add_f32 v57, 1.0, v57
  v_add_f32 v58, 1.0, v58
  v_add_f32 v59, 1.0, v59
  s_waitcnt lgkmcnt(4)
  v_mfma_f32_32x32x16_bf16 v[96:111], v[48:51], v[168:171], v[96:111]
  ds_read_b64_tr_b16 v[44:45], v13 offset:31744
  ds_read_b64_tr_b16 v[46:47], v13 offset:32512
  v_add_f32 v60, 1.0, v60
  v_add_f32 v61, 1.0, v61
  v_add_f32 v62, 1.0, v62
  v_add_f32 v63, 1.0, v63
  s_waitcnt lgkmcnt(4)
  v_mfma_f32_32x32x16_bf16 v[96:111], v[52:55], v[172:175], v[96:111]
  ds_read_b64_tr_b16 v[48:49], v13 offset:34816
  ds_read_b64_tr_b16 v[50:51], v13 offset:35584
  v_rcp_f32 v56, v56
  v_rcp_f32 v57, v57
  s_waitcnt lgkmcnt(4)
  v_mfma_f32_32x32x16_bf16 v[96:111], v[40:43], v[176:179], v[96:111]
  ds_read_b64_tr_b16 v[52:53], v13 offset:37888
  ds_read_b64_tr_b16 v[54:55], v13 offset:38656
  v_rcp_f32 v58, v58
  v_rcp_f32 v59, v59
  s_waitcnt lgkmcnt(4)
  v_mfma_f32_32x32x16_bf16 v[96:111], v[44:47], v[180:183], v[96:111]
  ds_read_b64_tr_b16 v[40:41], v14 offset:0
  ds_read_b64_tr_b16 v[42:43], v14 offset:768
  v_rcp_f32 v60, v60
  v_rcp_f32 v61, v61
  s_waitcnt lgkmcnt(4)
  v_mfma_f32_32x32x16_bf16 v[96:111], v[48:51], v[184:187], v[96:111]
  ds_read_b64_tr_b16 v[44:45], v14 offset:3072
  ds_read_b64_tr_b16 v[46:47], v14 offset:3840
  v_rcp_f32 v62, v62
  v_rcp_f32 v63, v63
  s_waitcnt lgkmcnt(4)
  v_mfma_f32_32x32x16_bf16 v[96:111], v[52:55], v[188:191], v[96:111]
  ds_read_b64_tr_b16 v[48:49], v14 offset:6144
  ds_read_b64_tr_b16 v[50:51], v14 offset:6912
  v_mul_f32 v72, v72, v56
  v_mul_f32 v73, v73, v57
  v_mul_f32 v74, v74, v58
  v_mul_f32 v75, v75, v59
  s_waitcnt lgkmcnt(4)
  v_mfma_f32_32x32x16_bf16 v[96:111], v[40:43], v[192:195], v[96:111]
  ds_read_b64_tr_b16 v[52:53], v14 offset:9216
  ds_read_b64_tr_b16 v[54:55], v14 offset:9984
  v_mul_f32 v76, v76, v60
  v_mul_f32 v77, v77, v61
  v_mul_f32 v78, v78, v62
  v_mul_f32 v79, v79, v63
  s_waitcnt lgkmcnt(4)
  v_mfma_f32_32x32x16_bf16 v[96:111], v[44:47], v[196:199], v[96:111]
  ds_read_b64_tr_b16 v[40:41], v12 offset:0
  ds_read_b64_tr_b16 v[42:43], v12 offset:768
  v_cvt_pk_bf16_f32 v18, v72, v73
  v_cvt_pk_bf16_f32 v19, v74, v75
  v_cvt_pk_bf16_f32 v20, v76, v77
  v_cvt_pk_bf16_f32 v21, v78, v79
  s_waitcnt lgkmcnt(4)
  v_mfma_f32_32x32x16_bf16 v[96:111], v[48:51], v[200:203], v[96:111]
  ds_read_b64_tr_b16 v[44:45], v12 offset:3072
  ds_read_b64_tr_b16 v[46:47], v12 offset:3840
  buffer_store_dwordx4 v[18:21], v15, s[28:31], s67 offen offset:1024 sc1
  s_nop 1
  ds_read_b128 v[56:59], v34 offset:64
  ds_read_b128 v[18:21], v34 offset:576
  ds_read_b128 v[60:63], v34 offset:96
  s_waitcnt lgkmcnt(7)
  v_mfma_f32_32x32x16_bf16 v[96:111], v[52:55], v[204:207], v[96:111]
  ds_read_b64_tr_b16 v[48:49], v12 offset:6144
  ds_read_b64_tr_b16 v[50:51], v12 offset:6912
  ds_read_b128 v[22:25], v34 offset:608
  v_fma_f32 v120, -v112, v30, v120
  v_fma_f32 v121, -v113, v30, v121
  v_fma_f32 v122, -v114, v30, v122
  s_waitcnt lgkmcnt(8)
  v_mfma_f32_32x32x16_bf16 v[96:111], v[40:43], v[208:211], v[96:111]
  ds_read_b64_tr_b16 v[52:53], v12 offset:9216
  ds_read_b64_tr_b16 v[54:55], v12 offset:9984
  v_fma_f32 v123, -v115, v30, v123
  v_fma_f32 v124, -v116, v30, v124
  v_fma_f32 v125, -v117, v30, v125
  v_fma_f32 v126, -v118, v30, v126
  s_waitcnt lgkmcnt(8)
  v_mfma_f32_32x32x16_bf16 v[96:111], v[44:47], v[212:215], v[96:111]
  ds_read_b64_tr_b16 v[40:41], v12 offset:12288
  ds_read_b64_tr_b16 v[42:43], v12 offset:13056
  v_fma_f32 v127, -v119, v30, v127
  v_fma_f32 v80, v80, v38, v120
  v_fma_f32 v81, v81, v38, v121
  v_fma_f32 v82, v82, v38, v122
  s_waitcnt lgkmcnt(5)
  v_mfma_f32_32x32x16_bf16 v[96:111], v[48:51], v[216:219], v[96:111]
  ds_read_b64_tr_b16 v[44:45], v12 offset:15360
  ds_read_b64_tr_b16 v[46:47], v12 offset:16128
  v_fma_f32 v83, v83, v38, v123
  v_fma_f32 v84, v84, v38, v124
  v_fma_f32 v85, v85, v38, v125
  v_fma_f32 v86, v86, v38, v126
  s_waitcnt lgkmcnt(4)
  v_mfma_f32_32x32x16_bf16 v[96:111], v[52:55], v[220:223], v[96:111]
  ds_read_b64_tr_b16 v[48:49], v12 offset:18432
  ds_read_b64_tr_b16 v[50:51], v12 offset:19200
  v_fma_f32 v87, v87, v38, v127
  v_mul_f32 v112, v80, v80
  v_mul_f32 v113, v81, v81
  v_mul_f32 v114, v82, v82
  s_waitcnt lgkmcnt(4)
  v_mfma_f32_32x32x16_bf16 v[96:111], v[40:43], v[224:227], v[96:111]
  ds_read_b64_tr_b16 v[52:53], v12 offset:21504
  ds_read_b64_tr_b16 v[54:55], v12 offset:22272
  v_mul_f32 v115, v83, v83
  v_mul_f32 v116, v84, v84
  v_mul_f32 v117, v85, v85
  v_mul_f32 v118, v86, v86
  s_waitcnt lgkmcnt(4)
  v_mfma_f32_32x32x16_bf16 v[96:111], v[44:47], v[228:231], v[96:111]
  ds_read_b64_tr_b16 v[40:41], v12 offset:28672
  ds_read_b64_tr_b16 v[42:43], v12 offset:29440
  v_mul_f32 v119, v87, v87
  v_fma_f32 v112, v112, s66, v32
  v_fma_f32 v113, v113, s66, v32
  v_fma_f32 v114, v114, s66, v32
  s_waitcnt lgkmcnt(4)
  v_mfma_f32_32x32x16_bf16 v[96:111], v[48:51], v[232:235], v[96:111]
  ds_read_b64_tr_b16 v[44:45], v12 offset:31744
  ds_read_b64_tr_b16 v[46:47], v12 offset:32512
  v_fma_f32 v115, v115, s66, v32
  v_fma_f32 v116, v116, s66, v32
  v_fma_f32 v117, v117, s66, v32
  v_fma_f32 v118, v118, s66, v32
  s_waitcnt lgkmcnt(4)
  v_mfma_f32_32x32x16_bf16 v[96:111], v[52:55], v[236:239], v[96:111]
  ds_read_b64_tr_b16 v[48:49], v12 offset:34816
  ds_read_b64_tr_b16 v[50:51], v12 offset:35584
  v_fma_f32 v119, v119, s66, v32
  v_mul_f32 v112, v112, v80
  v_mul_f32 v113, v113, v81
  v_mul_f32 v114, v114, v82
  s_waitcnt lgkmcnt(4)
  v_mfma_f32_32x32x16_bf16 v[96:111], v[40:43], v[240:243], v[96:111]
  ds_read_b64_tr_b16 v[52:53], v12 offset:37888
  ds_read_b64_tr_b16 v[54:55], v12 offset:38656
  v_mul_f32 v115, v115, v83
  v_mul_f32 v116, v116, v84
  v_mul_f32 v117, v117, v85
  v_mul_f32 v118, v118, v86
  s_waitcnt lgkmcnt(4)
  v_mfma_f32_32x32x16_bf16 v[96:111], v[44:47], v[244:247], v[96:111]
  v_mul_f32 v119, v119, v87
  v_exp_f32 v112, v112
  v_exp_f32 v113, v113
  s_waitcnt lgkmcnt(2)
  v_mfma_f32_32x32x16_bf16 v[96:111], v[48:51], v[248:251], v[96:111]
  v_exp_f32 v114, v114
  v_exp_f32 v115, v115
  s_waitcnt lgkmcnt(0)
  v_mfma_f32_32x32x16_bf16 v[96:111], v[52:55], v[252:255], v[96:111]
  v_exp_f32 v116, v116
  v_exp_f32 v117, v117
  s_mov_b64 exec, 1
  ds_add_u32 v17, v7
  s_mov_b64 exec, -1
  s_nop 7
  v_exp_f32 v118, v118
  v_exp_f32 v119, v119
  v_add_f32 v112, 1.0, v112
  v_add_f32 v113, 1.0, v113
  v_add_f32 v114, 1.0, v114
  v_add_f32 v115, 1.0, v115
  v_add_f32 v116, 1.0, v116
  v_add_f32 v117, 1.0, v117
  v_add_f32 v118, 1.0, v118
  v_add_f32 v119, 1.0, v119
  v_rcp_f32 v112, v112
  v_rcp_f32 v113, v113
  v_rcp_f32 v114, v114
  v_rcp_f32 v115, v115
  v_rcp_f32 v116, v116
  v_rcp_f32 v117, v117
  v_rcp_f32 v118, v118
  v_rcp_f32 v119, v119
  v_mul_f32 v80, v80, v112
  v_mul_f32 v81, v81, v113
  v_mul_f32 v82, v82, v114
  v_mul_f32 v83, v83, v115
  v_mul_f32 v84, v84, v116
  v_mul_f32 v85, v85, v117
  v_mul_f32 v86, v86, v118
  v_mul_f32 v87, v87, v119
  v_cvt_pk_bf16_f32 v120, v80, v81
  v_cvt_pk_bf16_f32 v121, v82, v83
  v_cvt_pk_bf16_f32 v122, v84, v85
  v_cvt_pk_bf16_f32 v123, v86, v87
  buffer_store_dwordx4 v[120:123], v15, s[28:31], s68 offen offset:0 sc1
  s_nop 1
  ds_read_b128 v[112:115], v35 offset:0
  ds_read_b128 v[120:123], v35 offset:512
  ds_read_b128 v[116:119], v35 offset:32
  ds_read_b128 v[124:127], v35 offset:544
  v_fma_f32 v18, -v56, v30, v18
  v_fma_f32 v19, -v57, v30, v19
  v_fma_f32 v20, -v58, v30, v20
  v_fma_f32 v21, -v59, v30, v21
  v_fma_f32 v22, -v60, v30, v22
  v_fma_f32 v23, -v61, v30, v23
  v_fma_f32 v24, -v62, v30, v24
  v_fma_f32 v25, -v63, v30, v25
  v_fma_f32 v88, v88, v38, v18
  v_fma_f32 v89, v89, v38, v19
  v_fma_f32 v90, v90, v38, v20
  v_fma_f32 v91, v91, v38, v21
  v_fma_f32 v92, v92, v38, v22
  v_fma_f32 v93, v93, v38, v23
  v_fma_f32 v94, v94, v38, v24
  v_fma_f32 v95, v95, v38, v25
  v_mul_f32 v56, v88, v88
  v_mul_f32 v57, v89, v89
  v_mul_f32 v58, v90, v90
  v_mul_f32 v59, v91, v91
  v_mul_f32 v60, v92, v92
  v_mul_f32 v61, v93, v93
  v_mul_f32 v62, v94, v94
  v_mul_f32 v63, v95, v95
  v_fma_f32 v56, v56, s66, v32
  v_fma_f32 v57, v57, s66, v32
  v_fma_f32 v58, v58, s66, v32
  v_fma_f32 v59, v59, s66, v32
  v_fma_f32 v60, v60, s66, v32
  v_fma_f32 v61, v61, s66, v32
  v_fma_f32 v62, v62, s66, v32
  v_fma_f32 v63, v63, s66, v32
  v_mul_f32 v56, v56, v88
  v_mul_f32 v57, v57, v89
  v_mul_f32 v58, v58, v90
  v_mul_f32 v59, v59, v91
  v_mul_f32 v60, v60, v92
  v_mul_f32 v61, v61, v93
  v_mul_f32 v62, v62, v94
  v_mul_f32 v63, v63, v95
  v_exp_f32 v56, v56
  v_exp_f32 v57, v57
  v_exp_f32 v58, v58
  v_exp_f32 v59, v59
  v_exp_f32 v60, v60
  v_exp_f32 v61, v61
  v_exp_f32 v62, v62
  v_exp_f32 v63, v63
  v_add_f32 v56, 1.0, v56
  v_add_f32 v57, 1.0, v57
  v_add_f32 v58, 1.0, v58
  v_add_f32 v59, 1.0, v59
  v_add_f32 v60, 1.0, v60
  v_add_f32 v61, 1.0, v61
  v_add_f32 v62, 1.0, v62
  v_add_f32 v63, 1.0, v63
  v_rcp_f32 v56, v56
  v_rcp_f32 v57, v57
  v_rcp_f32 v58, v58
  v_rcp_f32 v59, v59
  v_rcp_f32 v60, v60
  v_rcp_f32 v61, v61
  v_rcp_f32 v62, v62
  v_rcp_f32 v63, v63
  v_mul_f32 v88, v88, v56
  v_mul_f32 v89, v89, v57
  v_mul_f32 v90, v90, v58
  v_mul_f32 v91, v91, v59
  v_mul_f32 v92, v92, v60
  v_mul_f32 v93, v93, v61
  v_mul_f32 v94, v94, v62
  v_mul_f32 v95, v95, v63
  v_cvt_pk_bf16_f32 v18, v88, v89
  v_cvt_pk_bf16_f32 v19, v90, v91
  v_cvt_pk_bf16_f32 v20, v92, v93
  v_cvt_pk_bf16_f32 v21, v94, v95
  buffer_store_dwordx4 v[18:21], v15, s[28:31], s68 offen offset:1024 sc1
  s_nop 1
  ds_read_b128 v[56:59], v35 offset:64
  ds_read_b128 v[18:21], v35 offset:576
  ds_read_b128 v[60:63], v35 offset:96
  ds_read_b128 v[22:25], v35 offset:608
  s_waitcnt lgkmcnt(4)
  v_fma_f32 v120, -v112, v30, v120
  v_fma_f32 v121, -v113, v30, v121
  v_fma_f32 v122, -v114, v30, v122
  v_fma_f32 v123, -v115, v30, v123
  v_fma_f32 v124, -v116, v30, v124
  v_fma_f32 v125, -v117, v30, v125
  v_fma_f32 v126, -v118, v30, v126
  v_fma_f32 v127, -v119, v30, v127
  v_fma_f32 v96, v96, v38, v120
  v_fma_f32 v97, v97, v38, v121
  v_fma_f32 v98, v98, v38, v122
  v_fma_f32 v99, v99, v38, v123
  v_fma_f32 v100, v100, v38, v124
  v_fma_f32 v101, v101, v38, v125
  v_fma_f32 v102, v102, v38, v126
  v_fma_f32 v103, v103, v38, v127
  v_mul_f32 v112, v96, v96
  v_mul_f32 v113, v97, v97
  v_mul_f32 v114, v98, v98
  v_mul_f32 v115, v99, v99
  v_mul_f32 v116, v100, v100
  v_mul_f32 v117, v101, v101
  v_mul_f32 v118, v102, v102
  v_mul_f32 v119, v103, v103
  v_fma_f32 v112, v112, s66, v32
  v_fma_f32 v113, v113, s66, v32
  v_fma_f32 v114, v114, s66, v32
  v_fma_f32 v115, v115, s66, v32
  v_fma_f32 v116, v116, s66, v32
  v_fma_f32 v117, v117, s66, v32
  v_fma_f32 v118, v118, s66, v32
  v_fma_f32 v119, v119, s66, v32
  v_mul_f32 v112, v112, v96
  v_mul_f32 v113, v113, v97
  v_mul_f32 v114, v114, v98
  v_mul_f32 v115, v115, v99
  v_mul_f32 v116, v116, v100
  v_mul_f32 v117, v117, v101
  v_mul_f32 v118, v118, v102
  v_mul_f32 v119, v119, v103
  v_exp_f32 v112, v112
  v_exp_f32 v113, v113
  v_exp_f32 v114, v114
  v_exp_f32 v115, v115
  v_exp_f32 v116, v116
  v_exp_f32 v117, v117
  v_exp_f32 v118, v118
  v_exp_f32 v119, v119
  v_add_f32 v112, 1.0, v112
  v_add_f32 v113, 1.0, v113
  v_add_f32 v114, 1.0, v114
  v_add_f32 v115, 1.0, v115
  v_add_f32 v116, 1.0, v116
  v_add_f32 v117, 1.0, v117
  v_add_f32 v118, 1.0, v118
  v_add_f32 v119, 1.0, v119
  v_rcp_f32 v112, v112
  v_rcp_f32 v113, v113
  v_rcp_f32 v114, v114
  v_rcp_f32 v115, v115
  v_rcp_f32 v116, v116
  v_rcp_f32 v117, v117
  v_rcp_f32 v118, v118
  v_rcp_f32 v119, v119
  v_mul_f32 v96, v96, v112
  v_mul_f32 v97, v97, v113
  v_mul_f32 v98, v98, v114
  v_mul_f32 v99, v99, v115
  v_mul_f32 v100, v100, v116
  v_mul_f32 v101, v101, v117
  v_mul_f32 v102, v102, v118
  v_mul_f32 v103, v103, v119
  v_cvt_pk_bf16_f32 v120, v96, v97
  v_cvt_pk_bf16_f32 v121, v98, v99
  v_cvt_pk_bf16_f32 v122, v100, v101
  v_cvt_pk_bf16_f32 v123, v102, v103
  buffer_store_dwordx4 v[120:123], v15, s[28:31], s69 offen offset:0 sc1
  s_nop 1
  s_waitcnt lgkmcnt(0)
  v_fma_f32 v18, -v56, v30, v18
  v_fma_f32 v19, -v57, v30, v19
  v_fma_f32 v20, -v58, v30, v20
  v_fma_f32 v21, -v59, v30, v21
  v_fma_f32 v22, -v60, v30, v22
  v_fma_f32 v23, -v61, v30, v23
  v_fma_f32 v24, -v62, v30, v24
  v_fma_f32 v25, -v63, v30, v25
  v_fma_f32 v104, v104, v38, v18
  v_fma_f32 v105, v105, v38, v19
  v_fma_f32 v106, v106, v38, v20
  v_fma_f32 v107, v107, v38, v21
  v_fma_f32 v108, v108, v38, v22
  v_fma_f32 v109, v109, v38, v23
  v_fma_f32 v110, v110, v38, v24
  v_fma_f32 v111, v111, v38, v25
  v_mul_f32 v56, v104, v104
  v_mul_f32 v57, v105, v105
  v_mul_f32 v58, v106, v106
  v_mul_f32 v59, v107, v107
  v_mul_f32 v60, v108, v108
  v_mul_f32 v61, v109, v109
  v_mul_f32 v62, v110, v110
  v_mul_f32 v63, v111, v111
  v_fma_f32 v56, v56, s66, v32
  v_fma_f32 v57, v57, s66, v32
  v_fma_f32 v58, v58, s66, v32
  v_fma_f32 v59, v59, s66, v32
  v_fma_f32 v60, v60, s66, v32
  v_fma_f32 v61, v61, s66, v32
  v_fma_f32 v62, v62, s66, v32
  v_fma_f32 v63, v63, s66, v32
  v_mul_f32 v56, v56, v104
  v_mul_f32 v57, v57, v105
  v_mul_f32 v58, v58, v106
  v_mul_f32 v59, v59, v107
  v_mul_f32 v60, v60, v108
  v_mul_f32 v61, v61, v109
  v_mul_f32 v62, v62, v110
  v_mul_f32 v63, v63, v111
  v_exp_f32 v56, v56
  v_exp_f32 v57, v57
  v_exp_f32 v58, v58
  v_exp_f32 v59, v59
  v_exp_f32 v60, v60
  v_exp_f32 v61, v61
  v_exp_f32 v62, v62
  v_exp_f32 v63, v63
  v_add_f32 v56, 1.0, v56
  v_add_f32 v57, 1.0, v57
  v_add_f32 v58, 1.0, v58
  v_add_f32 v59, 1.0, v59
  v_add_f32 v60, 1.0, v60
  v_add_f32 v61, 1.0, v61
  v_add_f32 v62, 1.0, v62
  v_add_f32 v63, 1.0, v63
  v_rcp_f32 v56, v56
  v_rcp_f32 v57, v57
  v_rcp_f32 v58, v58
  v_rcp_f32 v59, v59
  v_rcp_f32 v60, v60
  v_rcp_f32 v61, v61
  v_rcp_f32 v62, v62
  v_rcp_f32 v63, v63
  v_mul_f32 v104, v104, v56
  v_mul_f32 v105, v105, v57
  v_mul_f32 v106, v106, v58
  v_mul_f32 v107, v107, v59
  v_mul_f32 v108, v108, v60
  v_mul_f32 v109, v109, v61
  v_mul_f32 v110, v110, v62
  v_mul_f32 v111, v111, v63
  v_cvt_pk_bf16_f32 v18, v104, v105
  v_cvt_pk_bf16_f32 v19, v106, v107
  v_cvt_pk_bf16_f32 v20, v108, v109
  v_cvt_pk_bf16_f32 v21, v110, v111
  buffer_store_dwordx4 v[18:21], v15, s[28:31], s69 offen offset:1024 sc1
  s_nop 1
  s_waitcnt vmcnt(0)
  s_lshl_b32 s48, s38, 4
  s_add_u32 s48, s48, s39
  s_lshl_b32 s48, s48, 7
  s_add_u32 s48, s48, 65536
  v_mov_b32 v40, 159748
  v_mov_b32 v41, 1
  s_mov_b64 exec, 1
  ds_add_rtn_u32 v42, v40, v41
  s_waitcnt lgkmcnt(0)
  v_readfirstlane_b32 s66, v42
  v_mov_b32 v40, s64
  v_mov_b32 v41, s65
  v_mov_b32 v42, 0
  s_cmp_eq_u32 s66, 3
  s_cbranch_scc0 SIG_6
  buffer_store_dwordx2 v[40:41], v42, s[28:31], s48 offen sc1
SIG_6:
  s_mov_b64 exec, -1
  s_setprio 0
  s_and_b32 s52, s2, 7
  s_lshr_b32 s53, s2, 3
  s_and_b32 s54, s53, 3
  s_lshl_b32 s52, s52, 2
  s_add_u32 s58, s52, s54
  s_lshr_b32 s59, s53, 2
  v_lshlrev_b32 v5, 4, v1
  v_lshlrev_b32 v8, 7, v1
  s_lshr_b32 s52, s2, 3
  s_lshl_b32 s52, s52, 2
  s_add_u32 s52, s52, s37
  s_lshl_b32 s52, s52, 14
  s_cmp_ge_u32 s52, 1409024
  s_cselect_b32 s24, s8, s16
  s_cselect_b32 s25, s9, s17
  s_cselect_b32 s53, 1409024, 0
  s_sub_u32 s52, s52, s53
  s_cmp_eq_u32 s53, 0
  s_mov_b32 s26, 524288
  s_cselect_b32 s26, 1409024, s26
  s_mov_b32 s27, 0x00020000
  s_lshr_b32 s52, s58, 1
  s_lshl_b32 s52, s52, 11
  s_add_u32 s52, s52, 65536
  v_mov_b32 v28, 159764
  s_cmp_eq_u32 s36, 4
  s_cbranch_scc0 PWO_7
  s_mov_b32 s66, 0xffff
  s_mov_b32 s67, 0
  s_mov_b32 s68, 1048576
  s_waitcnt vmcnt(0)
  s_mov_b64 exec, s[66:67]
POLL_9:
  buffer_load_dwordx2 v[26:27], v8, s[28:31], s52 offen sc1
  s_waitcnt vmcnt(0)
  v_cmp_eq_u64 vcc, s[64:65], v[26:27]
  s_sub_u32 s68, s68, 1
  s_cmp_eq_u32 s68, 0
  s_cbranch_scc1 POLLD_10
  s_cmp_eq_u64 vcc, s[66:67]
  s_cbranch_scc1 POLLD_10
  s_sleep 2
  s_branch POLL_9
POLLD_10:
  s_mov_b64 exec, -1
  v_mov_b32 v29, 1
  s_mov_b64 exec, 1
  ds_write_b32 v28, v29
  s_mov_b64 exec, -1
  s_waitcnt lgkmcnt(0)
  s_wakeup
  s_branch PWD_8
PWO_7:
PWL_11:
  ds_read_b32 v29, v28
  s_waitcnt lgkmcnt(0)
  v_readfirstlane_b32 s66, v29
  s_nop 0
  s_cmp_eq_u32 s66, 0
  s_cbranch_scc0 PWD_8
  s_sleep 8
  s_branch PWL_11
PWD_8:
  s_mov_b32 s24, s16
  s_mov_b32 s25, s17
  s_mov_b32 s26, 1409024
  s_mov_b32 s27, 0x00020000
  s_sub_u32 s60, s36, 4
  s_mul_i32 s61, s60, 22
  s_cmp_eq_u32 s60, 3
  s_cselect_b32 s52, 1, 0
  s_sub_u32 s61, s61, s52
  s_cmp_lt_u32 s60, 2
  s_cselect_b32 s62, 22, 21
  s_lshl_b32 s63, s59, 1
  s_and_b32 s52, s58, 3
  s_add_u32 s63, s63, s52
  s_sub_u32 s57, s62, s63
  s_add_u32 s61, s61, s63
  s_lshl_b32 s52, s58, 1
  s_mul_i32 s52, s52, 86
  s_add_u32 s52, s52, s61
  s_lshl_b32 s52, s52, 10
  s_add_u32 s52, s52, 9437184
  s_lshl_b32 s54, s61, 14
  s_lshl_b32 s55, s59, 7
  s_add_u32 s54, s54, s55
  s_lshl_b32 s56, s62, 10
  s_lshl_b32 s53, s62, 14
  s_mov_b32 s50, s57
  s_mul_i32 s55, s60, 20480
  s_add_u32 s55, s55, 73728
  v_lshrrev_b32 v10, 3, v1
  v_lshlrev_b32 v10, 10, v10
  v_and_b32 v11, 7, v1
  v_bfe_u32 v12, v1, 4, 1
  v_lshlrev_b32 v12, 2, v12
  v_xor_b32 v11, v11, v12
  v_lshlrev_b32 v11, 4, v11
  v_add_u32 v10, v10, v11
  v_add_u32 v11, 7168, v10
  v_add_u32 v17, 88064, v5
  v_bfe_u32 v13, v1, 2, 2
  v_lshlrev_b32 v14, 2, v4
  v_add_u32 v14, v14, v13
  v_lshlrev_b32 v14, 7, v14
  v_bfe_u32 v15, v1, 4, 1
  v_lshlrev_b32 v15, 1, v15
  v_and_b32 v16, 1, v1
  v_add_u32 v15, v15, v16
  v_lshrrev_b32 v13, 1, v13
  v_lshlrev_b32 v13, 2, v13
  v_xor_b32 v15, v15, v13
  v_lshlrev_b32 v15, 4, v15
  v_bfe_u32 v16, v1, 1, 1
  v_lshlrev_b32 v16, 3, v16
  v_add3_u32 v14, v14, v15, v16
  v_add_u32 v18, s55, v14
  v_xor_b32 v19, 64, v18
  s_add_u32 m0, s55, 0
  s_sub_u32 s50, s50, 1
  buffer_load_dwordx4 v10, s[24:27], s54 offen lds
  buffer_load_dwordx4 v11, s[24:27], s54 offen offset:1024 lds
  s_add_u32 s54, s54, 16384
  s_cmp_eq_u32 s50, 0
  s_cselect_b32 s63, s53, 0
  s_sub_u32 s54, s54, s63
  buffer_load_dwordx4 v[48:51], v5, s[28:31], s52 offen sc1
  buffer_load_dwordx4 v[52:55], v17, s[28:31], s52 offen sc1
  s_add_u32 s52, s52, 1024
  s_sub_u32 s57, s57, 1
  s_cmp_eq_u32 s57, 0
  s_cselect_b32 s63, s56, 0
  s_sub_u32 s52, s52, s63
  s_add_u32 m0, s55, 2048
  s_sub_u32 s50, s50, 1
  buffer_load_dwordx4 v10, s[24:27], s54 offen lds
  buffer_load_dwordx4 v11, s[24:27], s54 offen offset:1024 lds
  s_add_u32 s54, s54, 16384
  s_cmp_eq_u32 s50, 0
  s_cselect_b32 s63, s53, 0
  s_sub_u32 s54, s54, s63
  buffer_load_dwordx4 v[56:59], v5, s[28:31], s52 offen sc1
  buffer_load_dwordx4 v[60:63], v17, s[28:31], s52 offen sc1
  s_add_u32 s52, s52, 1024
  s_sub_u32 s57, s57, 1
  s_cmp_eq_u32 s57, 0
  s_cselect_b32 s63, s56, 0
  s_sub_u32 s52, s52, s63
  s_waitcnt vmcnt(0)
  s_add_u32 m0, s55, 4096
  s_sub_u32 s50, s50, 1
  buffer_load_dwordx4 v10, s[24:27], s54 offen lds
  buffer_load_dwordx4 v11, s[24:27], s54 offen offset:1024 lds
  s_add_u32 s54, s54, 16384
  s_cmp_eq_u32 s50, 0
  s_cselect_b32 s63, s53, 0
  s_sub_u32 s54, s54, s63
  buffer_load_dwordx4 v[64:67], v5, s[28:31], s52 offen sc1
  buffer_load_dwordx4 v[68:71], v17, s[28:31], s52 offen sc1
  s_add_u32 s52, s52, 1024
  s_sub_u32 s57, s57, 1
  s_cmp_eq_u32 s57, 0
  s_cselect_b32 s63, s56, 0
  s_sub_u32 s52, s52, s63
  s_add_u32 m0, s55, 6144
  s_sub_u32 s50, s50, 1
  buffer_load_dwordx4 v10, s[24:27], s54 offen lds
  buffer_load_dwordx4 v11, s[24:27], s54 offen offset:1024 lds
  s_add_u32 s54, s54, 16384
  s_cmp_eq_u32 s50, 0
  s_cselect_b32 s63, s53, 0
  s_sub_u32 s54, s54, s63
  buffer_load_dwordx4 v[72:75], v5, s[28:31], s52 offen sc1
  buffer_load_dwordx4 v[76:79], v17, s[28:31], s52 offen sc1
  s_add_u32 s52, s52, 1024
  s_sub_u32 s57, s57, 1
  s_cmp_eq_u32 s57, 0
  s_cselect_b32 s63, s56, 0
  s_sub_u32 s52, s52, s63
  s_waitcnt vmcnt(0)
  s_add_u32 m0, s55, 8192
  s_sub_u32 s50, s50, 1
  buffer_load_dwordx4 v10, s[24:27], s54 offen lds
  buffer_load_dwordx4 v11, s[24:27], s54 offen offset:1024 lds
  s_add_u32 s54, s54, 16384
  s_cmp_eq_u32 s50, 0
  s_cselect_b32 s63, s53, 0
  s_sub_u32 s54, s54, s63
  buffer_load_dwordx4 v[80:83], v5, s[28:31], s52 offen sc1
  buffer_load_dwordx4 v[84:87], v17, s[28:31], s52 offen sc1
  s_add_u32 s52, s52, 1024
  s_sub_u32 s57, s57, 1
  s_cmp_eq_u32 s57, 0
  s_cselect_b32 s63, s56, 0
  s_sub_u32 s52, s52, s63
  s_add_u32 m0, s55, 10240
  s_sub_u32 s50, s50, 1
  buffer_load_dwordx4 v10, s[24:27], s54 offen lds
  buffer_load_dwordx4 v11, s[24:27], s54 offen offset:1024 lds
  s_add_u32 s54, s54, 16384
  s_cmp_eq_u32 s50, 0
  s_cselect_b32 s63, s53, 0
  s_sub_u32 s54, s54, s63
  buffer_load_dwordx4 v[88:91], v5, s[28:31], s52 offen sc1
  buffer_load_dwordx4 v[92:95], v17, s[28:31], s52 offen sc1
  s_add_u32 s52, s52, 1024
  s_sub_u32 s57, s57, 1
  s_cmp_eq_u32 s57, 0
  s_cselect_b32 s63, s56, 0
  s_sub_u32 s52, s52, s63
  s_waitcnt vmcnt(0)
  s_add_u32 m0, s55, 12288
  s_sub_u32 s50, s50, 1
  buffer_load_dwordx4 v10, s[24:27], s54 offen lds
  buffer_load_dwordx4 v11, s[24:27], s54 offen offset:1024 lds
  s_add_u32 s54, s54, 16384
  s_cmp_eq_u32 s50, 0
  s_cselect_b32 s63, s53, 0
  s_sub_u32 s54, s54, s63
  buffer_load_dwordx4 v[96:99], v5, s[28:31], s52 offen sc1
  buffer_load_dwordx4 v[100:103], v17, s[28:31], s52 offen sc1
  s_add_u32 s52, s52, 1024
  s_sub_u32 s57, s57, 1
  s_cmp_eq_u32 s57, 0
  s_cselect_b32 s63, s56, 0
  s_sub_u32 s52, s52, s63
  s_add_u32 m0, s55, 14336
  s_sub_u32 s50, s50, 1
  buffer_load_dwordx4 v10, s[24:27], s54 offen lds
  buffer_load_dwordx4 v11, s[24:27], s54 offen offset:1024 lds
  s_add_u32 s54, s54, 16384
  s_cmp_eq_u32 s50, 0
  s_cselect_b32 s63, s53, 0
  s_sub_u32 s54, s54, s63
  buffer_load_dwordx4 v[104:107], v5, s[28:31], s52 offen sc1
  buffer_load_dwordx4 v[108:111], v17, s[28:31], s52 offen sc1
  s_add_u32 s52, s52, 1024
  s_sub_u32 s57, s57, 1
  s_cmp_eq_u32 s57, 0
  s_cselect_b32 s63, s56, 0
  s_sub_u32 s52, s52, s63
  s_waitcnt vmcnt(0)
  s_add_u32 m0, s55, 16384
  s_sub_u32 s50, s50, 1
  buffer_load_dwordx4 v10, s[24:27], s54 offen lds
  buffer_load_dwordx4 v11, s[24:27], s54 offen offset:1024 lds
  s_add_u32 s54, s54, 16384
  s_cmp_eq_u32 s50, 0
  s_cselect_b32 s63, s53, 0
  s_sub_u32 s54, s54, s63
  buffer_load_dwordx4 v[112:115], v5, s[28:31], s52 offen sc1
  buffer_load_dwordx4 v[116:119], v17, s[28:31], s52 offen sc1
  s_add_u32 s52, s52, 1024
  s_sub_u32 s57, s57, 1
  s_cmp_eq_u32 s57, 0
  s_cselect_b32 s63, s56, 0
  s_sub_u32 s52, s52, s63
  s_add_u32 m0, s55, 18432
  s_sub_u32 s50, s50, 1
  buffer_load_dwordx4 v10, s[24:27], s54 offen lds
  buffer_load_dwordx4 v11, s[24:27], s54 offen offset:1024 lds
  s_add_u32 s54, s54, 16384
  s_cmp_eq_u32 s50, 0
  s_cselect_b32 s63, s53, 0
  s_sub_u32 s54, s54, s63
  buffer_load_dwordx4 v[120:123], v5, s[28:31], s52 offen sc1
  buffer_load_dwordx4 v[124:127], v17, s[28:31], s52 offen sc1
  s_add_u32 s52, s52, 1024
  s_sub_u32 s57, s57, 1
  s_cmp_eq_u32 s57, 0
  s_cselect_b32 s63, s56, 0
  s_sub_u32 s52, s52, s63
  s_waitcnt vmcnt(0)
  buffer_load_dwordx4 v[128:131], v5, s[28:31], s52 offen sc1
  buffer_load_dwordx4 v[132:135], v17, s[28:31], s52 offen sc1
  s_add_u32 s52, s52, 1024
  s_sub_u32 s57, s57, 1
  s_cmp_eq_u32 s57, 0
  s_cselect_b32 s63, s56, 0
  s_sub_u32 s52, s52, s63
  buffer_load_dwordx4 v[136:139], v5, s[28:31], s52 offen sc1
  buffer_load_dwordx4 v[140:143], v17, s[28:31], s52 offen sc1
  s_add_u32 s52, s52, 1024
  s_sub_u32 s57, s57, 1
  s_cmp_eq_u32 s57, 0
  s_cselect_b32 s63, s56, 0
  s_sub_u32 s52, s52, s63
  buffer_load_dwordx4 v[144:147], v5, s[28:31], s52 offen sc1
  buffer_load_dwordx4 v[148:151], v17, s[28:31], s52 offen sc1
  s_add_u32 s52, s52, 1024
  s_sub_u32 s57, s57, 1
  s_cmp_eq_u32 s57, 0
  s_cselect_b32 s63, s56, 0
  s_sub_u32 s52, s52, s63
  s_waitcnt vmcnt(0)
  buffer_load_dwordx4 v[152:155], v5, s[28:31], s52 offen sc1
  buffer_load_dwordx4 v[156:159], v17, s[28:31], s52 offen sc1
  s_add_u32 s52, s52, 1024
  s_sub_u32 s57, s57, 1
  s_cmp_eq_u32 s57, 0
  s_cselect_b32 s63, s56, 0
  s_sub_u32 s52, s52, s63
  buffer_load_dwordx4 v[160:163], v5, s[28:31], s52 offen sc1
  buffer_load_dwordx4 v[164:167], v17, s[28:31], s52 offen sc1
  s_add_u32 s52, s52, 1024
  s_sub_u32 s57, s57, 1
  s_cmp_eq_u32 s57, 0
  s_cselect_b32 s63, s56, 0
  s_sub_u32 s52, s52, s63
  buffer_load_dwordx4 v[168:171], v5, s[28:31], s52 offen sc1
  buffer_load_dwordx4 v[172:175], v17, s[28:31], s52 offen sc1
  s_add_u32 s52, s52, 1024
  s_sub_u32 s57, s57, 1
  s_cmp_eq_u32 s57, 0
  s_cselect_b32 s63, s56, 0
  s_sub_u32 s52, s52, s63
  s_waitcnt vmcnt(0)
  buffer_load_dwordx4 v[176:179], v5, s[28:31], s52 offen sc1
  buffer_load_dwordx4 v[180:183], v17, s[28:31], s52 offen sc1
  s_add_u32 s52, s52, 1024
  s_sub_u32 s57, s57, 1
  s_cmp_eq_u32 s57, 0
  s_cselect_b32 s63, s56, 0
  s_sub_u32 s52, s52, s63
  buffer_load_dwordx4 v[184:187], v5, s[28:31], s52 offen sc1
  buffer_load_dwordx4 v[188:191], v17, s[28:31], s52 offen sc1
  s_add_u32 s52, s52, 1024
  s_sub_u32 s57, s57, 1
  s_cmp_eq_u32 s57, 0
  s_cselect_b32 s63, s56, 0
  s_sub_u32 s52, s52, s63
  v_mov_b32 v192, 0
  v_mov_b32 v193, 0
  v_mov_b32 v194, 0
  v_mov_b32 v195, 0
  v_mov_b32 v196, 0
  v_mov_b32 v197, 0
  v_mov_b32 v198, 0
  v_mov_b32 v199, 0
  v_mov_b32 v200, 0
  v_mov_b32 v201, 0
  v_mov_b32 v202, 0
  v_mov_b32 v203, 0
  v_mov_b32 v204, 0
  v_mov_b32 v205, 0
  v_mov_b32 v206, 0
  v_mov_b32 v207, 0
  v_mov_b32 v208, 0
  v_mov_b32 v209, 0
  v_mov_b32 v210, 0
  v_mov_b32 v211, 0
  v_mov_b32 v212, 0
  v_mov_b32 v213, 0
  v_mov_b32 v214, 0
  v_mov_b32 v215, 0
  v_mov_b32 v216, 0
  v_mov_b32 v217, 0
  v_mov_b32 v218, 0
  v_mov_b32 v219, 0
  v_mov_b32 v220, 0
  v_mov_b32 v221, 0
  v_mov_b32 v222, 0
  v_mov_b32 v223, 0
  v_mov_b32 v224, 0
  v_mov_b32 v225, 0
  v_mov_b32 v226, 0
  v_mov_b32 v227, 0
  v_mov_b32 v228, 0
  v_mov_b32 v229, 0
  v_mov_b32 v230, 0
  v_mov_b32 v231, 0
  v_mov_b32 v232, 0
  v_mov_b32 v233, 0
  v_mov_b32 v234, 0
  v_mov_b32 v235, 0
  v_mov_b32 v236, 0
  v_mov_b32 v237, 0
  v_mov_b32 v238, 0
  v_mov_b32 v239, 0
  v_mov_b32 v240, 0
  v_mov_b32 v241, 0
  v_mov_b32 v242, 0
  v_mov_b32 v243, 0
  v_mov_b32 v244, 0
  v_mov_b32 v245, 0
  v_mov_b32 v246, 0
  v_mov_b32 v247, 0
  v_mov_b32 v248, 0
  v_mov_b32 v249, 0
  v_mov_b32 v250, 0
  v_mov_b32 v251, 0
  v_mov_b32 v252, 0
  v_mov_b32 v253, 0
  v_mov_b32 v254, 0
  v_mov_b32 v255, 0
  s_mov_b32 s48, s54
  s_mov_b32 s49, s50
  s_waitcnt vmcnt(0)
  buffer_load_dwordx4 v[40:43], v10, s[24:27], s48 offen
  buffer_load_dwordx4 v[40:43], v11, s[24:27], s48 offen offset:1024
  s_add_u32 s48, s48, 16384
  s_sub_u32 s49, s49, 1
  s_cmp_eq_u32 s49, 0
  s_cselect_b32 s63, s53, 0
  s_sub_u32 s48, s48, s63
  buffer_load_dwordx4 v[40:43], v10, s[24:27], s48 offen
  buffer_load_dwordx4 v[40:43], v11, s[24:27], s48 offen offset:1024
  s_add_u32 s48, s48, 16384
  s_sub_u32 s49, s49, 1
  s_cmp_eq_u32 s49, 0
  s_cselect_b32 s63, s53, 0
  s_sub_u32 s48, s48, s63
  s_waitcnt vmcnt(0)
  buffer_load_dwordx4 v[40:43], v10, s[24:27], s48 offen
  buffer_load_dwordx4 v[40:43], v11, s[24:27], s48 offen offset:1024
  s_add_u32 s48, s48, 16384
  s_sub_u32 s49, s49, 1
  s_cmp_eq_u32 s49, 0
  s_cselect_b32 s63, s53, 0
  s_sub_u32 s48, s48, s63
  buffer_load_dwordx4 v[40:43], v10, s[24:27], s48 offen
  buffer_load_dwordx4 v[40:43], v11, s[24:27], s48 offen offset:1024
  s_add_u32 s48, s48, 16384
  s_sub_u32 s49, s49, 1
  s_cmp_eq_u32 s49, 0
  s_cselect_b32 s63, s53, 0
  s_sub_u32 s48, s48, s63
  s_waitcnt vmcnt(0)
  buffer_load_dwordx4 v[40:43], v10, s[24:27], s48 offen
  buffer_load_dwordx4 v[40:43], v11, s[24:27], s48 offen offset:1024
  s_add_u32 s48, s48, 16384
  s_sub_u32 s49, s49, 1
  s_cmp_eq_u32 s49, 0
  s_cselect_b32 s63, s53, 0
  s_sub_u32 s48, s48, s63
  buffer_load_dwordx4 v[40:43], v10, s[24:27], s48 offen
  buffer_load_dwordx4 v[40:43], v11, s[24:27], s48 offen offset:1024
  s_add_u32 s48, s48, 16384
  s_sub_u32 s49, s49, 1
  s_cmp_eq_u32 s49, 0
  s_cselect_b32 s63, s53, 0
  s_sub_u32 s48, s48, s63
  s_waitcnt vmcnt(0)
  buffer_load_dwordx4 v[40:43], v10, s[24:27], s48 offen
  buffer_load_dwordx4 v[40:43], v11, s[24:27], s48 offen offset:1024
  s_add_u32 s48, s48, 16384
  s_sub_u32 s49, s49, 1
  s_cmp_eq_u32 s49, 0
  s_cselect_b32 s63, s53, 0
  s_sub_u32 s48, s48, s63
  buffer_load_dwordx4 v[40:43], v10, s[24:27], s48 offen
  buffer_load_dwordx4 v[40:43], v11, s[24:27], s48 offen offset:1024
  s_add_u32 s48, s48, 16384
  s_sub_u32 s49, s49, 1
  s_cmp_eq_u32 s49, 0
  s_cselect_b32 s63, s53, 0
  s_sub_u32 s48, s48, s63
  s_waitcnt vmcnt(0)
  buffer_load_dwordx4 v[40:43], v10, s[24:27], s48 offen
  buffer_load_dwordx4 v[40:43], v11, s[24:27], s48 offen offset:1024
  s_add_u32 s48, s48, 16384
  s_sub_u32 s49, s49, 1
  s_cmp_eq_u32 s49, 0
  s_cselect_b32 s63, s53, 0
  s_sub_u32 s48, s48, s63
  buffer_load_dwordx4 v[40:43], v10, s[24:27], s48 offen
  buffer_load_dwordx4 v[40:43], v11, s[24:27], s48 offen offset:1024
  s_add_u32 s48, s48, 16384
  s_sub_u32 s49, s49, 1
  s_cmp_eq_u32 s49, 0
  s_cselect_b32 s63, s53, 0
  s_sub_u32 s48, s48, s63
  s_waitcnt vmcnt(0)
  buffer_load_dwordx4 v[40:43], v10, s[24:27], s48 offen
  buffer_load_dwordx4 v[40:43], v11, s[24:27], s48 offen offset:1024
  s_add_u32 s48, s48, 16384
  s_sub_u32 s49, s49, 1
  s_cmp_eq_u32 s49, 0
  s_cselect_b32 s63, s53, 0
  s_sub_u32 s48, s48, s63
  buffer_load_dwordx4 v[40:43], v10, s[24:27], s48 offen
  buffer_load_dwordx4 v[40:43], v11, s[24:27], s48 offen offset:1024
  s_add_u32 s48, s48, 16384
  s_sub_u32 s49, s49, 1
  s_cmp_eq_u32 s49, 0
  s_cselect_b32 s63, s53, 0
  s_sub_u32 s48, s48, s63
  s_waitcnt vmcnt(0)
  s_and_b32 s37, s36, 1
  s_bfe_u32 s38, s36, 0x10001
  s_lshr_b32 s39, s36, 2
  s_mov_b32 s32, s20
  s_mov_b32 s33, s21
  s_mov_b32 s34, 2097152
  s_mov_b32 s35, 0x00020000
  s_lshl_b32 s3, s58, 6
  s_lshl_b32 s42, s37, 5
  s_add_u32 s3, s3, s42
  v_add_u32 v20, s3, v3
  v_lshlrev_b32 v20, 10, v20
  s_lshl_b32 s3, s59, 6
  s_lshl_b32 s42, s38, 5
  s_add_u32 s3, s3, s42
  s_lshl_b32 s42, s39, 4
  s_add_u32 s3, s3, s42
  v_lshlrev_b32 v21, 3, v4
  v_add_u32 v21, s3, v21
  v_lshlrev_b32 v21, 1, v21
  v_add_u32 v20, v20, v21
  s_mov_b32 s44, s4
  s_mov_b32 s45, s5
  s_mov_b32 s46, 2097152
  s_mov_b32 s47, 0x00020000
  buffer_load_dwordx4 v[24:27], v20, s[44:47], 0 offen
  s_mov_b32 s44, s18
  s_mov_b32 s45, s19
  s_mov_b32 s46, 1024
  s_mov_b32 s47, 0x00020000
  buffer_load_dwordx4 v[28:31], v21, s[44:47], 0 offen
  s_lshl_b32 s3, s39, 15
  s_add_u32 s3, s3, 0
  v_bfe_u32 v13, v1, 2, 2
  v_lshlrev_b32 v14, 2, v4
  v_add_u32 v14, v14, v13
  v_lshlrev_b32 v14, 7, v14
  v_bfe_u32 v15, v1, 4, 1
  v_lshlrev_b32 v15, 1, v15
  v_and_b32 v16, 1, v1
  v_add_u32 v15, v15, v16
  v_lshrrev_b32 v13, 1, v13
  v_lshlrev_b32 v13, 2, v13
  v_xor_b32 v15, v15, v13
  v_lshlrev_b32 v15, 4, v15
  v_bfe_u32 v16, v1, 1, 1
  v_lshlrev_b32 v16, 3, v16
  v_add3_u32 v14, v14, v15, v16
  v_add_u32 v21, s3, v14
  v_xor_b32 v22, 64, v21
  s_lshl_b32 s3, s38, 6
  v_xor_b32 v21, s3, v21
  s_lshl_b32 s3, s37, 15
  s_lshl_b32 s42, s39, 14
  s_add_u32 s3, s3, s42
  s_add_u32 s3, s3, 65536
  v_add_u32 v22, s3, v5
  s_lshl_b32 s3, s38, 4
  s_lshl_b32 s42, s39, 1
  s_add_u32 s3, s3, s42
  s_lshl_b32 s40, s58, 1
  s_add_u32 s40, s40, s37
  s_lshl_b32 s40, s40, 5
  s_add_u32 s40, s40, s3
  s_lshl_b32 s40, s40, 10
  s_add_u32 s40, s40, 7340032
  s_lshl_b32 s41, s37, 5
  s_add_u32 s41, s41, s3
  s_lshl_b32 s41, s41, 10
  s_add_u32 s41, s41, 65536
  s_and_b32 s3, s36, 3
  s_lshl_b32 s3, s3, 12
  s_add_u32 s3, s3, 131072
  s_lshl_b32 s42, s39, 11
  s_add_u32 s43, s3, s42
  v_add_u32 v23, s43, v5
  s_xor_b32 s42, s42, 2048
  s_add_u32 s43, s3, s42
  v_add_u32 v6, s43, v5
  s_lshr_b32 s42, s58, 2
  s_lshl_b32 s42, s42, 12
  s_add_u32 s42, s42, 98304
  s_waitcnt vmcnt(0)
  v_lshlrev_b32 v40, 16, v24
  v_and_b32 v41, 0xffff0000, v24
  v_lshlrev_b32 v42, 16, v25
  v_and_b32 v43, 0xffff0000, v25
  v_lshlrev_b32 v44, 16, v26
  v_and_b32 v45, 0xffff0000, v26
  v_lshlrev_b32 v46, 16, v27
  v_and_b32 v47, 0xffff0000, v27
  v_lshlrev_b32 v24, 16, v28
  v_and_b32 v25, 0xffff0000, v28
  v_add_f32 v40, v40, v24
  v_add_f32 v41, v41, v25
  v_lshlrev_b32 v24, 16, v29
  v_and_b32 v25, 0xffff0000, v29
  v_add_f32 v42, v42, v24
  v_add_f32 v43, v43, v25
  v_lshlrev_b32 v24, 16, v30
  v_and_b32 v25, 0xffff0000, v30
  v_add_f32 v44, v44, v24
  v_add_f32 v45, v45, v25
  v_lshlrev_b32 v24, 16, v31
  v_and_b32 v25, 0xffff0000, v31
  v_add_f32 v46, v46, v24
  v_add_f32 v47, v47, v25
  v_mov_b32 v12, 159776
G2W_12:
  ds_read_b32 v13, v12
  s_waitcnt lgkmcnt(0)
  v_readfirstlane_b32 s3, v13
  s_nop 0
  s_cmp_ge_u32 s3, 4
  s_cbranch_scc1 G2WD_13
  s_sleep 16
  s_branch G2W_12
G2WD_13:
  s_setprio 2
  s_waitcnt vmcnt(0)
  ds_read_b64_tr_b16 v[24:25], v18 offset:0
  ds_read_b64_tr_b16 v[26:27], v18 offset:1024
  ds_read_b64_tr_b16 v[28:29], v19 offset:0
  ds_read_b64_tr_b16 v[30:31], v19 offset:1024
  ds_read_b64_tr_b16 v[32:33], v18 offset:2048
  ds_read_b64_tr_b16 v[34:35], v18 offset:3072
  ds_read_b64_tr_b16 v[36:37], v19 offset:2048
  ds_read_b64_tr_b16 v[38:39], v19 offset:3072
  s_waitcnt lgkmcnt(4)
  v_mfma_f32_32x32x16_bf16 v[192:207], v[24:27], v[48:51], v[192:207]
  v_mfma_f32_32x32x16_bf16 v[208:223], v[28:31], v[48:51], v[208:223]
  v_mfma_f32_32x32x16_bf16 v[224:239], v[24:27], v[52:55], v[224:239]
  v_mfma_f32_32x32x16_bf16 v[240:255], v[28:31], v[52:55], v[240:255]
  s_add_u32 m0, s55, 0
  s_sub_u32 s50, s50, 1
  buffer_load_dwordx4 v10, s[24:27], s54 offen lds
  buffer_load_dwordx4 v11, s[24:27], s54 offen offset:1024 lds
  s_add_u32 s54, s54, 16384
  s_cmp_eq_u32 s50, 0
  s_cselect_b32 s63, s53, 0
  s_sub_u32 s54, s54, s63
  buffer_load_dwordx4 v[48:51], v5, s[28:31], s52 offen sc1
  buffer_load_dwordx4 v[52:55], v17, s[28:31], s52 offen sc1
  s_add_u32 s52, s52, 1024
  s_sub_u32 s57, s57, 1
  s_cmp_eq_u32 s57, 0
  s_cselect_b32 s63, s56, 0
  s_sub_u32 s52, s52, s63
  ds_read_b64_tr_b16 v[24:25], v18 offset:4096
  ds_read_b64_tr_b16 v[26:27], v18 offset:5120
  ds_read_b64_tr_b16 v[28:29], v19 offset:4096
  ds_read_b64_tr_b16 v[30:31], v19 offset:5120
  s_waitcnt lgkmcnt(4)
  v_mfma_f32_32x32x16_bf16 v[192:207], v[32:35], v[56:59], v[192:207]
  v_mfma_f32_32x32x16_bf16 v[208:223], v[36:39], v[56:59], v[208:223]
  v_mfma_f32_32x32x16_bf16 v[224:239], v[32:35], v[60:63], v[224:239]
  v_mfma_f32_32x32x16_bf16 v[240:255], v[36:39], v[60:63], v[240:255]
  s_add_u32 m0, s55, 2048
  s_sub_u32 s50, s50, 1
  buffer_load_dwordx4 v10, s[24:27], s54 offen lds
  buffer_load_dwordx4 v11, s[24:27], s54 offen offset:1024 lds
  s_add_u32 s54, s54, 16384
  s_cmp_eq_u32 s50, 0
  s_cselect_b32 s63, s53, 0
  s_sub_u32 s54, s54, s63
  buffer_load_dwordx4 v[56:59], v5, s[28:31], s52 offen sc1
  buffer_load_dwordx4 v[60:63], v17, s[28:31], s52 offen sc1
  s_add_u32 s52, s52, 1024
  s_sub_u32 s57, s57, 1
  s_cmp_eq_u32 s57, 0
  s_cselect_b32 s63, s56, 0
  s_sub_u32 s52, s52, s63
  ds_read_b64_tr_b16 v[32:33], v18 offset:6144
  ds_read_b64_tr_b16 v[34:35], v18 offset:7168
  ds_read_b64_tr_b16 v[36:37], v19 offset:6144
  ds_read_b64_tr_b16 v[38:39], v19 offset:7168
  s_waitcnt lgkmcnt(4)
  v_mfma_f32_32x32x16_bf16 v[192:207], v[24:27], v[64:67], v[192:207]
  v_mfma_f32_32x32x16_bf16 v[208:223], v[28:31], v[64:67], v[208:223]
  v_mfma_f32_32x32x16_bf16 v[224:239], v[24:27], v[68:71], v[224:239]
  v_mfma_f32_32x32x16_bf16 v[240:255], v[28:31], v[68:71], v[240:255]
  s_add_u32 m0, s55, 4096
  s_sub_u32 s50, s50, 1
  buffer_load_dwordx4 v10, s[24:27], s54 offen lds
  buffer_load_dwordx4 v11, s[24:27], s54 offen offset:1024 lds
  s_add_u32 s54, s54, 16384
  s_cmp_eq_u32 s50, 0
  s_cselect_b32 s63, s53, 0
  s_sub_u32 s54, s54, s63
  buffer_load_dwordx4 v[64:67], v5, s[28:31], s52 offen sc1
  buffer_load_dwordx4 v[68:71], v17, s[28:31], s52 offen sc1
  s_add_u32 s52, s52, 1024
  s_sub_u32 s57, s57, 1
  s_cmp_eq_u32 s57, 0
  s_cselect_b32 s63, s56, 0
  s_sub_u32 s52, s52, s63
  ds_read_b64_tr_b16 v[24:25], v18 offset:8192
  ds_read_b64_tr_b16 v[26:27], v18 offset:9216
  ds_read_b64_tr_b16 v[28:29], v19 offset:8192
  ds_read_b64_tr_b16 v[30:31], v19 offset:9216
  s_waitcnt lgkmcnt(4)
  v_mfma_f32_32x32x16_bf16 v[192:207], v[32:35], v[72:75], v[192:207]
  v_mfma_f32_32x32x16_bf16 v[208:223], v[36:39], v[72:75], v[208:223]
  v_mfma_f32_32x32x16_bf16 v[224:239], v[32:35], v[76:79], v[224:239]
  v_mfma_f32_32x32x16_bf16 v[240:255], v[36:39], v[76:79], v[240:255]
  s_add_u32 m0, s55, 6144
  s_sub_u32 s50, s50, 1
  buffer_load_dwordx4 v10, s[24:27], s54 offen lds
  buffer_load_dwordx4 v11, s[24:27], s54 offen offset:1024 lds
  s_add_u32 s54, s54, 16384
  s_cmp_eq_u32 s50, 0
  s_cselect_b32 s63, s53, 0
  s_sub_u32 s54, s54, s63
  buffer_load_dwordx4 v[72:75], v5, s[28:31], s52 offen sc1
  buffer_load_dwordx4 v[76:79], v17, s[28:31], s52 offen sc1
  s_add_u32 s52, s52, 1024
  s_sub_u32 s57, s57, 1
  s_cmp_eq_u32 s57, 0
  s_cselect_b32 s63, s56, 0
  s_sub_u32 s52, s52, s63
  ds_read_b64_tr_b16 v[32:33], v18 offset:10240
  ds_read_b64_tr_b16 v[34:35], v18 offset:11264
  ds_read_b64_tr_b16 v[36:37], v19 offset:10240
  ds_read_b64_tr_b16 v[38:39], v19 offset:11264
  s_waitcnt lgkmcnt(4)
  v_mfma_f32_32x32x16_bf16 v[192:207], v[24:27], v[80:83], v[192:207]
  v_mfma_f32_32x32x16_bf16 v[208:223], v[28:31], v[80:83], v[208:223]
  v_mfma_f32_32x32x16_bf16 v[224:239], v[24:27], v[84:87], v[224:239]
  v_mfma_f32_32x32x16_bf16 v[240:255], v[28:31], v[84:87], v[240:255]
  s_add_u32 m0, s55, 8192
  s_sub_u32 s50, s50, 1
  buffer_load_dwordx4 v10, s[24:27], s54 offen lds
  buffer_load_dwordx4 v11, s[24:27], s54 offen offset:1024 lds
  s_add_u32 s54, s54, 16384
  s_cmp_eq_u32 s50, 0
  s_cselect_b32 s63, s53, 0
  s_sub_u32 s54, s54, s63
  ds_read_b64_tr_b16 v[24:25], v18 offset:12288
  ds_read_b64_tr_b16 v[26:27], v18 offset:13312
  ds_read_b64_tr_b16 v[28:29], v19 offset:12288
  ds_read_b64_tr_b16 v[30:31], v19 offset:13312
  s_waitcnt lgkmcnt(4)
  v_mfma_f32_32x32x16_bf16 v[192:207], v[32:35], v[88:91], v[192:207]
  v_mfma_f32_32x32x16_bf16 v[208:223], v[36:39], v[88:91], v[208:223]
  v_mfma_f32_32x32x16_bf16 v[224:239], v[32:35], v[92:95], v[224:239]
  v_mfma_f32_32x32x16_bf16 v[240:255], v[36:39], v[92:95], v[240:255]
  s_add_u32 m0, s55, 10240
  s_sub_u32 s50, s50, 1
  buffer_load_dwordx4 v10, s[24:27], s54 offen lds
  buffer_load_dwordx4 v11, s[24:27], s54 offen offset:1024 lds
  s_add_u32 s54, s54, 16384
  s_cmp_eq_u32 s50, 0
  s_cselect_b32 s63, s53, 0
  s_sub_u32 s54, s54, s63
  ds_read_b64_tr_b16 v[32:33], v18 offset:14336
  ds_read_b64_tr_b16 v[34:35], v18 offset:15360
  ds_read_b64_tr_b16 v[36:37], v19 offset:14336
  ds_read_b64_tr_b16 v[38:39], v19 offset:15360
  s_waitcnt lgkmcnt(4)
  v_mfma_f32_32x32x16_bf16 v[192:207], v[24:27], v[96:99], v[192:207]
  v_mfma_f32_32x32x16_bf16 v[208:223], v[28:31], v[96:99], v[208:223]
  v_mfma_f32_32x32x16_bf16 v[224:239], v[24:27], v[100:103], v[224:239]
  v_mfma_f32_32x32x16_bf16 v[240:255], v[28:31], v[100:103], v[240:255]
  s_add_u32 m0, s55, 12288
  s_sub_u32 s50, s50, 1
  buffer_load_dwordx4 v10, s[24:27], s54 offen lds
  buffer_load_dwordx4 v11, s[24:27], s54 offen offset:1024 lds
  s_add_u32 s54, s54, 16384
  s_cmp_eq_u32 s50, 0
  s_cselect_b32 s63, s53, 0
  s_sub_u32 s54, s54, s63
  ds_read_b64_tr_b16 v[24:25], v18 offset:16384
  ds_read_b64_tr_b16 v[26:27], v18 offset:17408
  ds_read_b64_tr_b16 v[28:29], v19 offset:16384
  ds_read_b64_tr_b16 v[30:31], v19 offset:17408
  s_waitcnt lgkmcnt(4)
  v_mfma_f32_32x32x16_bf16 v[192:207], v[32:35], v[104:107], v[192:207]
  v_mfma_f32_32x32x16_bf16 v[208:223], v[36:39], v[104:107], v[208:223]
  v_mfma_f32_32x32x16_bf16 v[224:239], v[32:35], v[108:111], v[224:239]
  v_mfma_f32_32x32x16_bf16 v[240:255], v[36:39], v[108:111], v[240:255]
  s_add_u32 m0, s55, 14336
  s_sub_u32 s50, s50, 1
  buffer_load_dwordx4 v10, s[24:27], s54 offen lds
  buffer_load_dwordx4 v11, s[24:27], s54 offen offset:1024 lds
  s_add_u32 s54, s54, 16384
  s_cmp_eq_u32 s50, 0
  s_cselect_b32 s63, s53, 0
  s_sub_u32 s54, s54, s63
  ds_read_b64_tr_b16 v[32:33], v18 offset:18432
  ds_read_b64_tr_b16 v[34:35], v18 offset:19456
  ds_read_b64_tr_b16 v[36:37], v19 offset:18432
  ds_read_b64_tr_b16 v[38:39], v19 offset:19456
  s_waitcnt lgkmcnt(4)
  v_mfma_f32_32x32x16_bf16 v[192:207], v[24:27], v[112:115], v[192:207]
  v_mfma_f32_32x32x16_bf16 v[208:223], v[28:31], v[112:115], v[208:223]
  v_mfma_f32_32x32x16_bf16 v[224:239], v[24:27], v[116:119], v[224:239]
  v_mfma_f32_32x32x16_bf16 v[240:255], v[28:31], v[116:119], v[240:255]
  s_add_u32 m0, s55, 16384
  s_sub_u32 s50, s50, 1
  buffer_load_dwordx4 v10, s[24:27], s54 offen lds
  buffer_load_dwordx4 v11, s[24:27], s54 offen offset:1024 lds
  s_add_u32 s54, s54, 16384
  s_cmp_eq_u32 s50, 0
  s_cselect_b32 s63, s53, 0
  s_sub_u32 s54, s54, s63
  s_waitcnt vmcnt(24)
  ds_read_b64_tr_b16 v[24:25], v18 offset:0
  ds_read_b64_tr_b16 v[26:27], v18 offset:1024
  ds_read_b64_tr_b16 v[28:29], v19 offset:0
  ds_read_b64_tr_b16 v[30:31], v19 offset:1024
  s_waitcnt lgkmcnt(4)
  v_mfma_f32_32x32x16_bf16 v[192:207], v[32:35], v[120:123], v[192:207]
  v_mfma_f32_32x32x16_bf16 v[208:223], v[36:39], v[120:123], v[208:223]
  v_mfma_f32_32x32x16_bf16 v[224:239], v[32:35], v[124:127], v[224:239]
  v_mfma_f32_32x32x16_bf16 v[240:255], v[36:39], v[124:127], v[240:255]
  s_add_u32 m0, s55, 18432
  s_sub_u32 s50, s50, 1
  buffer_load_dwordx4 v10, s[24:27], s54 offen lds
  buffer_load_dwordx4 v11, s[24:27], s54 offen offset:1024 lds
  s_add_u32 s54, s54, 16384
  s_cmp_eq_u32 s50, 0
  s_cselect_b32 s63, s53, 0
  s_sub_u32 s54, s54, s63
  s_waitcnt vmcnt(22)
  ds_read_b64_tr_b16 v[32:33], v18 offset:2048
  ds_read_b64_tr_b16 v[34:35], v18 offset:3072
  ds_read_b64_tr_b16 v[36:37], v19 offset:2048
  ds_read_b64_tr_b16 v[38:39], v19 offset:3072
  s_waitcnt lgkmcnt(4)
  v_mfma_f32_32x32x16_bf16 v[192:207], v[24:27], v[128:131], v[192:207]
  v_mfma_f32_32x32x16_bf16 v[208:223], v[28:31], v[128:131], v[208:223]
  v_mfma_f32_32x32x16_bf16 v[224:239], v[24:27], v[132:135], v[224:239]
  v_mfma_f32_32x32x16_bf16 v[240:255], v[28:31], v[132:135], v[240:255]
  s_add_u32 m0, s55, 0
  s_sub_u32 s50, s50, 1
  buffer_load_dwordx4 v10, s[24:27], s54 offen lds
  buffer_load_dwordx4 v11, s[24:27], s54 offen offset:1024 lds
  s_add_u32 s54, s54, 16384
  s_cmp_eq_u32 s50, 0
  s_cselect_b32 s63, s53, 0
  s_sub_u32 s54, s54, s63
  s_waitcnt vmcnt(20)
  ds_read_b64_tr_b16 v[24:25], v18 offset:4096
  ds_read_b64_tr_b16 v[26:27], v18 offset:5120
  ds_read_b64_tr_b16 v[28:29], v19 offset:4096
  ds_read_b64_tr_b16 v[30:31], v19 offset:5120
  s_waitcnt lgkmcnt(4)
  v_mfma_f32_32x32x16_bf16 v[192:207], v[32:35], v[136:139], v[192:207]
  v_mfma_f32_32x32x16_bf16 v[208:223], v[36:39], v[136:139], v[208:223]
  v_mfma_f32_32x32x16_bf16 v[224:239], v[32:35], v[140:143], v[224:239]
  v_mfma_f32_32x32x16_bf16 v[240:255], v[36:39], v[140:143], v[240:255]
  s_add_u32 m0, s55, 2048
  s_sub_u32 s50, s50, 1
  buffer_load_dwordx4 v10, s[24:27], s54 offen lds
  buffer_load_dwordx4 v11, s[24:27], s54 offen offset:1024 lds
  s_add_u32 s54, s54, 16384
  s_cmp_eq_u32 s50, 0
  s_cselect_b32 s63, s53, 0
  s_sub_u32 s54, s54, s63
  s_waitcnt vmcnt(18)
  ds_read_b64_tr_b16 v[32:33], v18 offset:6144
  ds_read_b64_tr_b16 v[34:35], v18 offset:7168
  ds_read_b64_tr_b16 v[36:37], v19 offset:6144
  ds_read_b64_tr_b16 v[38:39], v19 offset:7168
  s_waitcnt lgkmcnt(4)
  v_mfma_f32_32x32x16_bf16 v[192:207], v[24:27], v[144:147], v[192:207]
  v_mfma_f32_32x32x16_bf16 v[208:223], v[28:31], v[144:147], v[208:223]
  v_mfma_f32_32x32x16_bf16 v[224:239], v[24:27], v[148:151], v[224:239]
  v_mfma_f32_32x32x16_bf16 v[240:255], v[28:31], v[148:151], v[240:255]
  s_waitcnt vmcnt(14)
  ds_read_b64_tr_b16 v[24:25], v18 offset:8192
  ds_read_b64_tr_b16 v[26:27], v18 offset:9216
  ds_read_b64_tr_b16 v[28:29], v19 offset:8192
  ds_read_b64_tr_b16 v[30:31], v19 offset:9216
  s_waitcnt lgkmcnt(4)
  v_mfma_f32_32x32x16_bf16 v[192:207], v[32:35], v[152:155], v[192:207]
  v_mfma_f32_32x32x16_bf16 v[208:223], v[36:39], v[152:155], v[208:223]
  v_mfma_f32_32x32x16_bf16 v[224:239], v[32:35], v[156:159], v[224:239]
  v_mfma_f32_32x32x16_bf16 v[240:255], v[36:39], v[156:159], v[240:255]
  s_waitcnt vmcnt(12)
  ds_read_b64_tr_b16 v[32:33], v18 offset:10240
  ds_read_b64_tr_b16 v[34:35], v18 offset:11264
  ds_read_b64_tr_b16 v[36:37], v19 offset:10240
  ds_read_b64_tr_b16 v[38:39], v19 offset:11264
  s_waitcnt lgkmcnt(4)
  v_mfma_f32_32x32x16_bf16 v[192:207], v[24:27], v[160:163], v[192:207]
  v_mfma_f32_32x32x16_bf16 v[208:223], v[28:31], v[160:163], v[208:223]
  v_mfma_f32_32x32x16_bf16 v[224:239], v[24:27], v[164:167], v[224:239]
  v_mfma_f32_32x32x16_bf16 v[240:255], v[28:31], v[164:167], v[240:255]
  s_waitcnt vmcnt(10)
  ds_read_b64_tr_b16 v[24:25], v18 offset:12288
  ds_read_b64_tr_b16 v[26:27], v18 offset:13312
  ds_read_b64_tr_b16 v[28:29], v19 offset:12288
  ds_read_b64_tr_b16 v[30:31], v19 offset:13312
  s_waitcnt lgkmcnt(4)
  v_mfma_f32_32x32x16_bf16 v[192:207], v[32:35], v[168:171], v[192:207]
  v_mfma_f32_32x32x16_bf16 v[208:223], v[36:39], v[168:171], v[208:223]
  v_mfma_f32_32x32x16_bf16 v[224:239], v[32:35], v[172:175], v[224:239]
  v_mfma_f32_32x32x16_bf16 v[240:255], v[36:39], v[172:175], v[240:255]
  s_waitcnt vmcnt(8)
  ds_read_b64_tr_b16 v[32:33], v18 offset:14336
  ds_read_b64_tr_b16 v[34:35], v18 offset:15360
  ds_read_b64_tr_b16 v[36:37], v19 offset:14336
  ds_read_b64_tr_b16 v[38:39], v19 offset:15360
  s_waitcnt lgkmcnt(4)
  v_mfma_f32_32x32x16_bf16 v[192:207], v[24:27], v[176:179], v[192:207]
  v_mfma_f32_32x32x16_bf16 v[208:223], v[28:31], v[176:179], v[208:223]
  v_mfma_f32_32x32x16_bf16 v[224:239], v[24:27], v[180:183], v[224:239]
  v_mfma_f32_32x32x16_bf16 v[240:255], v[28:31], v[180:183], v[240:255]
  s_waitcnt vmcnt(6)
  ds_read_b64_tr_b16 v[24:25], v18 offset:16384
  ds_read_b64_tr_b16 v[26:27], v18 offset:17408
  ds_read_b64_tr_b16 v[28:29], v19 offset:16384
  ds_read_b64_tr_b16 v[30:31], v19 offset:17408
  s_waitcnt lgkmcnt(4)
  v_mfma_f32_32x32x16_bf16 v[192:207], v[32:35], v[184:187], v[192:207]
  v_mfma_f32_32x32x16_bf16 v[208:223], v[36:39], v[184:187], v[208:223]
  v_mfma_f32_32x32x16_bf16 v[224:239], v[32:35], v[188:191], v[224:239]
  v_mfma_f32_32x32x16_bf16 v[240:255], v[36:39], v[188:191], v[240:255]
  s_waitcnt vmcnt(4)
  ds_read_b64_tr_b16 v[32:33], v18 offset:18432
  ds_read_b64_tr_b16 v[34:35], v18 offset:19456
  ds_read_b64_tr_b16 v[36:37], v19 offset:18432
  ds_read_b64_tr_b16 v[38:39], v19 offset:19456
  s_waitcnt lgkmcnt(4)
  v_mfma_f32_32x32x16_bf16 v[192:207], v[24:27], v[48:51], v[192:207]
  v_mfma_f32_32x32x16_bf16 v[208:223], v[28:31], v[48:51], v[208:223]
  v_mfma_f32_32x32x16_bf16 v[224:239], v[24:27], v[52:55], v[224:239]
  v_mfma_f32_32x32x16_bf16 v[240:255], v[28:31], v[52:55], v[240:255]
  s_waitcnt vmcnt(2)
  ds_read_b64_tr_b16 v[24:25], v18 offset:0
  ds_read_b64_tr_b16 v[26:27], v18 offset:1024
  ds_read_b64_tr_b16 v[28:29], v19 offset:0
  ds_read_b64_tr_b16 v[30:31], v19 offset:1024
  s_waitcnt lgkmcnt(4)
  v_mfma_f32_32x32x16_bf16 v[192:207], v[32:35], v[56:59], v[192:207]
  v_mfma_f32_32x32x16_bf16 v[208:223], v[36:39], v[56:59], v[208:223]
  v_mfma_f32_32x32x16_bf16 v[224:239], v[32:35], v[60:63], v[224:239]
  v_mfma_f32_32x32x16_bf16 v[240:255], v[36:39], v[60:63], v[240:255]
  s_waitcnt vmcnt(0)
  ds_read_b64_tr_b16 v[32:33], v18 offset:2048
  ds_read_b64_tr_b16 v[34:35], v18 offset:3072
  ds_read_b64_tr_b16 v[36:37], v19 offset:2048
  ds_read_b64_tr_b16 v[38:39], v19 offset:3072
  s_waitcnt lgkmcnt(4)
  v_mfma_f32_32x32x16_bf16 v[192:207], v[24:27], v[64:67], v[192:207]
  v_mfma_f32_32x32x16_bf16 v[208:223], v[28:31], v[64:67], v[208:223]
  v_mfma_f32_32x32x16_bf16 v[224:239], v[24:27], v[68:71], v[224:239]
  v_mfma_f32_32x32x16_bf16 v[240:255], v[28:31], v[68:71], v[240:255]
  s_waitcnt lgkmcnt(0)
  s_cmp_eq_u32 s62, 21
  s_cbranch_scc1 K_G2_DONE
  v_mfma_f32_32x32x16_bf16 v[192:207], v[32:35], v[72:75], v[192:207]
  v_mfma_f32_32x32x16_bf16 v[208:223], v[36:39], v[72:75], v[208:223]
  v_mfma_f32_32x32x16_bf16 v[224:239], v[32:35], v[76:79], v[224:239]
  v_mfma_f32_32x32x16_bf16 v[240:255], v[36:39], v[76:79], v[240:255]
K_G2_DONE:
  s_waitcnt vmcnt(0) lgkmcnt(0)
  s_nop 7
  s_cmp_eq_u32 s60, 0
  s_cbranch_scc1 GXS_14
  s_sub_u32 s52, 3, s60
  s_and_b32 s52, s52, 3
  s_lshl_b32 s52, s52, 12
  s_add_u32 s52, s52, s55
  v_add_u32 v14, s52, v5
  ds_write_b128 v14, v[192:195] offset:0
  ds_write_b128 v14, v[196:199] offset:1024
  ds_write_b128 v14, v[200:203] offset:2048
  ds_write_b128 v14, v[204:207] offset:3072
GXS_14:
  s_cmp_eq_u32 s60, 2
  s_cbranch_scc1 GXS_15
  s_sub_u32 s52, 5, s60
  s_and_b32 s52, s52, 3
  s_lshl_b32 s52, s52, 12
  s_add_u32 s52, s52, s55
  v_add_u32 v14, s52, v5
  ds_write_b128 v14, v[208:211] offset:0
  ds_write_b128 v14, v[212:215] offset:1024
  ds_write_b128 v14, v[216:219] offset:2048
  ds_write_b128 v14, v[220:223] offset:3072
GXS_15:
  s_cmp_eq_u32 s60, 1
  s_cbranch_scc1 GXS_16
  s_sub_u32 s52, 4, s60
  s_and_b32 s52, s52, 3
  s_lshl_b32 s52, s52, 12
  s_add_u32 s52, s52, s55
  v_add_u32 v14, s52, v5
  ds_write_b128 v14, v[224:227] offset:0
  ds_write_b128 v14, v[228:231] offset:1024
  ds_write_b128 v14, v[232:235] offset:2048
  ds_write_b128 v14, v[236:239] offset:3072
GXS_16:
  s_cmp_eq_u32 s60, 3
  s_cbranch_scc1 GXS_17
  s_sub_u32 s52, 6, s60
  s_and_b32 s52, s52, 3
  s_lshl_b32 s52, s52, 12
  s_add_u32 s52, s52, s55
  v_add_u32 v14, s52, v5
  ds_write_b128 v14, v[240:243] offset:0
  ds_write_b128 v14, v[244:247] offset:1024
  ds_write_b128 v14, v[248:251] offset:2048
  ds_write_b128 v14, v[252:255] offset:3072
GXS_17:
  v_mov_b32 v12, 159756
  v_mov_b32 v13, 1
  s_waitcnt lgkmcnt(0)
  s_mov_b64 exec, 1
  ds_add_u32 v12, v13
  s_mov_b64 exec, -1
GB_18:
  ds_read_b32 v13, v12
  s_waitcnt lgkmcnt(0)
  v_readfirstlane_b32 s3, v13
  s_nop 0
  s_cmp_ge_u32 s3, 24
  s_cbranch_scc0 GB_18
  s_sub_u32 s52, s60, 1
  s_and_b32 s52, s52, 3
  s_mul_i32 s52, s52, 20480
  s_add_u32 s52, s52, 73728
  v_add_u32 v14, s52, v5
  ds_read_b128 v[128:131], v14 offset:0
  ds_read_b128 v[132:135], v14 offset:1024
  ds_read_b128 v[136:139], v14 offset:2048
  ds_read_b128 v[140:143], v14 offset:3072
  s_sub_u32 s52, s60, 2
  s_and_b32 s52, s52, 3
  s_mul_i32 s52, s52, 20480
  s_add_u32 s52, s52, 77824
  v_add_u32 v14, s52, v5
  ds_read_b128 v[144:147], v14 offset:0
  ds_read_b128 v[148:151], v14 offset:1024
  ds_read_b128 v[152:155], v14 offset:2048
  ds_read_b128 v[156:159], v14 offset:3072
  s_sub_u32 s52, s60, 3
  s_and_b32 s52, s52, 3
  s_mul_i32 s52, s52, 20480
  s_add_u32 s52, s52, 81920
  v_add_u32 v14, s52, v5
  ds_read_b128 v[160:163], v14 offset:0
  ds_read_b128 v[164:167], v14 offset:1024
  ds_read_b128 v[168:171], v14 offset:2048
  ds_read_b128 v[172:175], v14 offset:3072
  s_waitcnt lgkmcnt(8)
  s_cmp_lg_u32 s60, 0
  s_cbranch_scc1 GXQ_20
  v_add_f32 v192, v192, v128
  v_add_f32 v193, v193, v129
  v_add_f32 v194, v194, v130
  v_add_f32 v195, v195, v131
  v_add_f32 v196, v196, v132
  v_add_f32 v197, v197, v133
  v_add_f32 v198, v198, v134
  v_add_f32 v199, v199, v135
  v_add_f32 v200, v200, v136
  v_add_f32 v201, v201, v137
  v_add_f32 v202, v202, v138
  v_add_f32 v203, v203, v139
  v_add_f32 v204, v204, v140
  v_add_f32 v205, v205, v141
  v_add_f32 v206, v206, v142
  v_add_f32 v207, v207, v143
  s_branch GXE_19
GXQ_20:
  s_cmp_lg_u32 s60, 1
  s_cbranch_scc1 GXQ_21
  v_add_f32 v192, v224, v128
  v_add_f32 v193, v225, v129
  v_add_f32 v194, v226, v130
  v_add_f32 v195, v227, v131
  v_add_f32 v196, v228, v132
  v_add_f32 v197, v229, v133
  v_add_f32 v198, v230, v134
  v_add_f32 v199, v231, v135
  v_add_f32 v200, v232, v136
  v_add_f32 v201, v233, v137
  v_add_f32 v202, v234, v138
  v_add_f32 v203, v235, v139
  v_add_f32 v204, v236, v140
  v_add_f32 v205, v237, v141
  v_add_f32 v206, v238, v142
  v_add_f32 v207, v239, v143
  s_branch GXE_19
GXQ_21:
  s_cmp_lg_u32 s60, 2
  s_cbranch_scc1 GXQ_22
  v_add_f32 v192, v208, v128
  v_add_f32 v193, v209, v129
  v_add_f32 v194, v210, v130
  v_add_f32 v195, v211, v131
  v_add_f32 v196, v212, v132
  v_add_f32 v197, v213, v133
  v_add_f32 v198, v214, v134
  v_add_f32 v199, v215, v135
  v_add_f32 v200, v216, v136
  v_add_f32 v201, v217, v137
  v_add_f32 v202, v218, v138
  v_add_f32 v203, v219, v139
  v_add_f32 v204, v220, v140
  v_add_f32 v205, v221, v141
  v_add_f32 v206, v222, v142
  v_add_f32 v207, v223, v143
  s_branch GXE_19
GXQ_22:
  v_add_f32 v192, v240, v128
  v_add_f32 v193, v241, v129
  v_add_f32 v194, v242, v130
  v_add_f32 v195, v243, v131
  v_add_f32 v196, v244, v132
  v_add_f32 v197, v245, v133
  v_add_f32 v198, v246, v134
  v_add_f32 v199, v247, v135
  v_add_f32 v200, v248, v136
  v_add_f32 v201, v249, v137
  v_add_f32 v202, v250, v138
  v_add_f32 v203, v251, v139
  v_add_f32 v204, v252, v140
  v_add_f32 v205, v253, v141
  v_add_f32 v206, v254, v142
  v_add_f32 v207, v255, v143
GXE_19:
  s_waitcnt lgkmcnt(4)
  v_add_f32 v192, v192, v144
  v_add_f32 v193, v193, v145
  v_add_f32 v194, v194, v146
  v_add_f32 v195, v195, v147
  v_add_f32 v196, v196, v148
  v_add_f32 v197, v197, v149
  v_add_f32 v198, v198, v150
  v_add_f32 v199, v199, v151
  v_add_f32 v200, v200, v152
  v_add_f32 v201, v201, v153
  v_add_f32 v202, v202, v154
  v_add_f32 v203, v203, v155
  v_add_f32 v204, v204, v156
  v_add_f32 v205, v205, v157
  v_add_f32 v206, v206, v158
  v_add_f32 v207, v207, v159
  s_waitcnt lgkmcnt(0)
  v_add_f32 v192, v192, v160
  v_add_f32 v193, v193, v161
  v_add_f32 v194, v194, v162
  v_add_f32 v195, v195, v163
  v_add_f32 v196, v196, v164
  v_add_f32 v197, v197, v165
  v_add_f32 v198, v198, v166
  v_add_f32 v199, v199, v167
  v_add_f32 v200, v200, v168
  v_add_f32 v201, v201, v169
  v_add_f32 v202, v202, v170
  v_add_f32 v203, v203, v171
  v_add_f32 v204, v204, v172
  v_add_f32 v205, v205, v173
  v_add_f32 v206, v206, v174
  v_add_f32 v207, v207, v175
  s_branch K_TAIL
K_G0:
  v_bfe_u32 v5, v1, 1, 3
  v_xor_b32 v5, v5, v4
  v_lshlrev_b32 v5, 4, v5
  s_lshl_b32 s3, s37, 12
  v_lshlrev_b32 v6, 7, v3
  v_add3_u32 v12, v6, v5, s3
  v_xor_b32 v13, 32, v12
  v_xor_b32 v14, 64, v12
  v_xor_b32 v15, 0x60, v12
  v_lshlrev_b32 v6, 3, v4
  v_bfe_u32 v7, v1, 2, 2
  v_add_u32 v6, v6, v7
  v_mul_u32_u24 v6, 192, v6
  v_bfe_u32 v7, v1, 4, 1
  v_lshlrev_b32 v7, 5, v7
  v_and_b32 v8, 3, v1
  v_lshlrev_b32 v8, 3, v8
  v_add3_u32 v16, v6, v7, v8
  v_mov_b32 v64, 0
  v_mov_b32 v65, 0
  v_mov_b32 v66, 0
  v_mov_b32 v67, 0
  v_mov_b32 v68, 0
  v_mov_b32 v69, 0
  v_mov_b32 v70, 0
  v_mov_b32 v71, 0
  v_mov_b32 v72, 0
  v_mov_b32 v73, 0
  v_mov_b32 v74, 0
  v_mov_b32 v75, 0
  v_mov_b32 v76, 0
  v_mov_b32 v77, 0
  v_mov_b32 v78, 0
  v_mov_b32 v79, 0
  v_mov_b32 v80, 0
  v_mov_b32 v81, 0
  v_mov_b32 v82, 0
  v_mov_b32 v83, 0
  v_mov_b32 v84, 0
  v_mov_b32 v85, 0
  v_mov_b32 v86, 0
  v_mov_b32 v87, 0
  v_mov_b32 v88, 0
  v_mov_b32 v89, 0
  v_mov_b32 v90, 0
  v_mov_b32 v91, 0
  v_mov_b32 v92, 0
  v_mov_b32 v93, 0
  v_mov_b32 v94, 0
  v_mov_b32 v95, 0
  v_mov_b32 v96, 0
  v_mov_b32 v97, 0
  v_mov_b32 v98, 0
  v_mov_b32 v99, 0
  v_mov_b32 v100, 0
  v_mov_b32 v101, 0
  v_mov_b32 v102, 0
  v_mov_b32 v103, 0
  v_mov_b32 v104, 0
  v_mov_b32 v105, 0
  v_mov_b32 v106, 0
  v_mov_b32 v107, 0
  v_mov_b32 v108, 0
  v_mov_b32 v109, 0
  v_mov_b32 v110, 0
  v_mov_b32 v111, 0
  v_add_u32 v17, 16384, v16
  s_mov_b32 s56, 0xfffe4000
  s_mov_b32 s57, 28672
  v_lshlrev_b32 v18, 2, v1
  v_add_u32 v18, 159744, v18
  v_mov_b32 v19, 0
  s_mov_b64 exec, 0xffff
  ds_write_b32 v18, v19
  s_mov_b64 exec, -1
  s_lshl_b32 s48, s37, 7
  v_lshlrev_b32 v20, 2, v3
  v_add_u32 v20, s48, v20
  v_add_u32 v20, 155648, v20
  v_lshlrev_b32 v23, 4, v4
  v_add_u32 v24, 156672, v23
  v_lshlrev_b32 v25, 2, v3
  v_add_u32 v25, 156928, v25
  v_add_u32 v27, s48, v23
  v_add_u32 v27, 155648, v27
  s_lshl_b32 s49, s38, 2
  s_add_u32 s49, s49, s37
  s_lshl_b32 s50, s49, 10
  s_lshl_b32 s51, s39, 17
  s_add_u32 s50, s50, s51
  s_add_u32 s52, s50, 3145728
  s_add_u32 s53, s50, 3211264
  s_add_u32 s54, s50, 5242880
  s_add_u32 s51, s50, 1114112
  s_add_u32 s50, s50, 1048576
  v_lshlrev_b32 v28, 4, v1
  v_and_b32 v29, 0x13, v3
  v_bfe_u32 v30, v3, 2, 1
  v_lshlrev_b32 v30, 3, v30
  v_bfe_u32 v31, v3, 3, 1
  v_lshlrev_b32 v31, 2, v31
  v_or3_b32 v29, v29, v30, v31
  v_lshlrev_b32 v30, 5, v4
  v_add_u32 v29, v29, v30
  v_lshlrev_b32 v29, 4, v29
  v_bfe_u32 v30, v3, 4, 1
  v_lshlrev_b32 v30, 16, v30
  v_lshlrev_b32 v31, 8, v4
  v_and_b32 v32, 15, v3
  v_lshlrev_b32 v32, 4, v32
  v_add3_u32 v30, v30, v31, v32
  s_mul_i32 s55, s39, 1536
  s_lshl_b32 s58, s49, 2
  s_add_u32 s55, s55, s58
  s_add_u32 s55, s55, 262144
  v_lshlrev_b32 v31, 8, v4
  s_waitcnt lgkmcnt(0)
  s_mov_b32 s28, s22
  s_mov_b32 s29, s23
  s_mov_b32 s30, 16777216
  s_mov_b32 s31, 0x00020000
  s_load_dwordx2 s[64:65], s[22:23], 0
  s_waitcnt lgkmcnt(0)
  s_add_u32 s64, s64, 0x7f4a7c15
  s_addc_u32 s65, s65, 0x9e3779b9
  s_barrier
  ds_read_b128 v[128:131], v12
  ds_read_b64_tr_b16 v[132:133], v17 offset:0
  ds_read_b64_tr_b16 v[134:135], v17 offset:768
  ds_read_b64_tr_b16 v[136:137], v17 offset:64
  ds_read_b64_tr_b16 v[138:139], v17 offset:832
  ds_read_b64_tr_b16 v[140:141], v17 offset:128
  ds_read_b64_tr_b16 v[142:143], v17 offset:896
  ds_read_b128 v[144:147], v13
  ds_read_b64_tr_b16 v[148:149], v17 offset:3072
  ds_read_b64_tr_b16 v[150:151], v17 offset:3840
  ds_read_b64_tr_b16 v[152:153], v17 offset:3136
  ds_read_b64_tr_b16 v[154:155], v17 offset:3904
  ds_read_b64_tr_b16 v[156:157], v17 offset:3200
  ds_read_b64_tr_b16 v[158:159], v17 offset:3968
  s_waitcnt lgkmcnt(7)
  v_mfma_f32_32x32x16_bf16 v[64:79], v[132:135], v[128:131], v[64:79]
  ds_read_b128 v[160:163], v14
  ds_read_b64_tr_b16 v[164:165], v17 offset:6144
  ds_read_b64_tr_b16 v[166:167], v17 offset:6912
  v_mfma_f32_32x32x16_bf16 v[80:95], v[136:139], v[128:131], v[80:95]
  ds_read_b64_tr_b16 v[168:169], v17 offset:6208
  ds_read_b64_tr_b16 v[170:171], v17 offset:6976
  v_mfma_f32_32x32x16_bf16 v[96:111], v[128:131], v[140:143], v[96:111]
  ds_read_b64_tr_b16 v[172:173], v17 offset:6272
  ds_read_b64_tr_b16 v[174:175], v17 offset:7040
  s_waitcnt lgkmcnt(7)
  v_mfma_f32_32x32x16_bf16 v[64:79], v[148:151], v[144:147], v[64:79]
  ds_read_b128 v[176:179], v15
  ds_read_b64_tr_b16 v[180:181], v17 offset:9216
  ds_read_b64_tr_b16 v[182:183], v17 offset:9984
  v_mfma_f32_32x32x16_bf16 v[80:95], v[152:155], v[144:147], v[80:95]
  ds_read_b64_tr_b16 v[184:185], v17 offset:9280
  ds_read_b64_tr_b16 v[186:187], v17 offset:10048
  v_mfma_f32_32x32x16_bf16 v[96:111], v[144:147], v[156:159], v[96:111]
  ds_read_b64_tr_b16 v[188:189], v17 offset:9344
  ds_read_b64_tr_b16 v[190:191], v17 offset:10112
  v_add_u32 v12, s57, v12
  v_add_u32 v13, s57, v13
  v_add_u32 v14, s57, v14
  v_add_u32 v15, s57, v15
  v_add_u32 v17, s57, v17
  s_barrier
  s_waitcnt lgkmcnt(7)
  v_mfma_f32_32x32x16_bf16 v[64:79], v[164:167], v[160:163], v[64:79]
  ds_read_b128 v[128:131], v12
  ds_read_b64_tr_b16 v[132:133], v17 offset:0
  ds_read_b64_tr_b16 v[134:135], v17 offset:768
  v_mfma_f32_32x32x16_bf16 v[80:95], v[168:171], v[160:163], v[80:95]
  ds_read_b64_tr_b16 v[136:137], v17 offset:64
  ds_read_b64_tr_b16 v[138:139], v17 offset:832
  v_mfma_f32_32x32x16_bf16 v[96:111], v[160:163], v[172:175], v[96:111]
  ds_read_b64_tr_b16 v[140:141], v17 offset:128
  ds_read_b64_tr_b16 v[142:143], v17 offset:896
  s_waitcnt lgkmcnt(7)
  v_mfma_f32_32x32x16_bf16 v[64:79], v[180:183], v[176:179], v[64:79]
  ds_read_b128 v[144:147], v13
  ds_read_b64_tr_b16 v[148:149], v17 offset:3072
  ds_read_b64_tr_b16 v[150:151], v17 offset:3840
  v_mfma_f32_32x32x16_bf16 v[80:95], v[184:187], v[176:179], v[80:95]
  ds_read_b64_tr_b16 v[152:153], v17 offset:3136
  ds_read_b64_tr_b16 v[154:155], v17 offset:3904
  v_mfma_f32_32x32x16_bf16 v[96:111], v[176:179], v[188:191], v[96:111]
  ds_read_b64_tr_b16 v[156:157], v17 offset:3200
  ds_read_b64_tr_b16 v[158:159], v17 offset:3968
  s_waitcnt lgkmcnt(7)
  v_mfma_f32_32x32x16_bf16 v[64:79], v[132:135], v[128:131], v[64:79]
  ds_read_b128 v[160:163], v14
  ds_read_b64_tr_b16 v[164:165], v17 offset:6144
  ds_read_b64_tr_b16 v[166:167], v17 offset:6912
  v_mfma_f32_32x32x16_bf16 v[80:95], v[136:139], v[128:131], v[80:95]
  ds_read_b64_tr_b16 v[168:169], v17 offset:6208
  ds_read_b64_tr_b16 v[170:171], v17 offset:6976
  v_mfma_f32_32x32x16_bf16 v[96:111], v[128:131], v[140:143], v[96:111]
  ds_read_b64_tr_b16 v[172:173], v17 offset:6272
  ds_read_b64_tr_b16 v[174:175], v17 offset:7040
  s_waitcnt lgkmcnt(7)
  v_mfma_f32_32x32x16_bf16 v[64:79], v[148:151], v[144:147], v[64:79]
  ds_read_b128 v[176:179], v15
  ds_read_b64_tr_b16 v[180:181], v17 offset:9216
  ds_read_b64_tr_b16 v[182:183], v17 offset:9984
  v_mfma_f32_32x32x16_bf16 v[80:95], v[152:155], v[144:147], v[80:95]
  ds_read_b64_tr_b16 v[184:185], v17 offset:9280
  ds_read_b64_tr_b16 v[186:187], v17 offset:10048
  v_mfma_f32_32x32x16_bf16 v[96:111], v[144:147], v[156:159], v[96:111]
  ds_read_b64_tr_b16 v[188:189], v17 offset:9344
  ds_read_b64_tr_b16 v[190:191], v17 offset:10112
  v_add_u32 v12, s57, v12
  v_add_u32 v13, s57, v13
  v_add_u32 v14, s57, v14
  v_add_u32 v15, s57, v15
  v_add_u32 v17, s57, v17
  s_barrier
  s_waitcnt lgkmcnt(7)
  v_mfma_f32_32x32x16_bf16 v[64:79], v[164:167], v[160:163], v[64:79]
  ds_read_b128 v[128:131], v12
  ds_read_b64_tr_b16 v[132:133], v17 offset:0
  ds_read_b64_tr_b16 v[134:135], v17 offset:768
  v_mfma_f32_32x32x16_bf16 v[80:95], v[168:171], v[160:163], v[80:95]
  ds_read_b64_tr_b16 v[136:137], v17 offset:64
  ds_read_b64_tr_b16 v[138:139], v17 offset:832
  v_mfma_f32_32x32x16_bf16 v[96:111], v[160:163], v[172:175], v[96:111]
  ds_read_b64_tr_b16 v[140:141], v17 offset:128
  ds_read_b64_tr_b16 v[142:143], v17 offset:896
  s_waitcnt lgkmcnt(7)
  v_mfma_f32_32x32x16_bf16 v[64:79], v[180:183], v[176:179], v[64:79]
  ds_read_b128 v[144:147], v13
  ds_read_b64_tr_b16 v[148:149], v17 offset:3072
  ds_read_b64_tr_b16 v[150:151], v17 offset:3840
  v_mfma_f32_32x32x16_bf16 v[80:95], v[184:187], v[176:179], v[80:95]
  ds_read_b64_tr_b16 v[152:153], v17 offset:3136
  ds_read_b64_tr_b16 v[154:155], v17 offset:3904
  v_mfma_f32_32x32x16_bf16 v[96:111], v[176:179], v[188:191], v[96:111]
  ds_read_b64_tr_b16 v[156:157], v17 offset:3200
  ds_read_b64_tr_b16 v[158:159], v17 offset:3968
  s_waitcnt lgkmcnt(7)
  v_mfma_f32_32x32x16_bf16 v[64:79], v[132:135], v[128:131], v[64:79]
  ds_read_b128 v[160:163], v14
  ds_read_b64_tr_b16 v[164:165], v17 offset:6144
  ds_read_b64_tr_b16 v[166:167], v17 offset:6912
  v_mfma_f32_32x32x16_bf16 v[80:95], v[136:139], v[128:131], v[80:95]
  ds_read_b64_tr_b16 v[168:169], v17 offset:6208
  ds_read_b64_tr_b16 v[170:171], v17 offset:6976
  v_mfma_f32_32x32x16_bf16 v[96:111], v[128:131], v[140:143], v[96:111]
  ds_read_b64_tr_b16 v[172:173], v17 offset:6272
  ds_read_b64_tr_b16 v[174:175], v17 offset:7040
  s_waitcnt lgkmcnt(7)
  v_mfma_f32_32x32x16_bf16 v[64:79], v[148:151], v[144:147], v[64:79]
  ds_read_b128 v[176:179], v15
  ds_read_b64_tr_b16 v[180:181], v17 offset:9216
  ds_read_b64_tr_b16 v[182:183], v17 offset:9984
  v_mfma_f32_32x32x16_bf16 v[80:95], v[152:155], v[144:147], v[80:95]
  ds_read_b64_tr_b16 v[184:185], v17 offset:9280
  ds_read_b64_tr_b16 v[186:187], v17 offset:10048
  v_mfma_f32_32x32x16_bf16 v[96:111], v[144:147], v[156:159], v[96:111]
  ds_read_b64_tr_b16 v[188:189], v17 offset:9344
  ds_read_b64_tr_b16 v[190:191], v17 offset:10112
  v_add_u32 v12, s57, v12
  v_add_u32 v13, s57, v13
  v_add_u32 v14, s57, v14
  v_add_u32 v15, s57, v15
  v_add_u32 v17, s57, v17
  s_barrier
  s_waitcnt lgkmcnt(7)
  v_mfma_f32_32x32x16_bf16 v[64:79], v[164:167], v[160:163], v[64:79]
  ds_read_b128 v[128:131], v12
  ds_read_b64_tr_b16 v[132:133], v17 offset:0
  ds_read_b64_tr_b16 v[134:135], v17 offset:768
  v_mfma_f32_32x32x16_bf16 v[80:95], v[168:171], v[160:163], v[80:95]
  ds_read_b64_tr_b16 v[136:137], v17 offset:64
  ds_read_b64_tr_b16 v[138:139], v17 offset:832
  v_mfma_f32_32x32x16_bf16 v[96:111], v[160:163], v[172:175], v[96:111]
  ds_read_b64_tr_b16 v[140:141], v17 offset:128
  ds_read_b64_tr_b16 v[142:143], v17 offset:896
  s_waitcnt lgkmcnt(7)
  v_mfma_f32_32x32x16_bf16 v[64:79], v[180:183], v[176:179], v[64:79]
  ds_read_b128 v[144:147], v13
  ds_read_b64_tr_b16 v[148:149], v17 offset:3072
  ds_read_b64_tr_b16 v[150:151], v17 offset:3840
  v_mfma_f32_32x32x16_bf16 v[80:95], v[184:187], v[176:179], v[80:95]
  ds_read_b64_tr_b16 v[152:153], v17 offset:3136
  ds_read_b64_tr_b16 v[154:155], v17 offset:3904
  v_mfma_f32_32x32x16_bf16 v[96:111], v[176:179], v[188:191], v[96:111]
  ds_read_b64_tr_b16 v[156:157], v17 offset:3200
  ds_read_b64_tr_b16 v[158:159], v17 offset:3968
  s_waitcnt lgkmcnt(7)
  v_mfma_f32_32x32x16_bf16 v[64:79], v[132:135], v[128:131], v[64:79]
  ds_read_b128 v[160:163], v14
  ds_read_b64_tr_b16 v[164:165], v17 offset:6144
  ds_read_b64_tr_b16 v[166:167], v17 offset:6912
  v_mfma_f32_32x32x16_bf16 v[80:95], v[136:139], v[128:131], v[80:95]
  ds_read_b64_tr_b16 v[168:169], v17 offset:6208
  ds_read_b64_tr_b16 v[170:171], v17 offset:6976
  v_mfma_f32_32x32x16_bf16 v[96:111], v[128:131], v[140:143], v[96:111]
  ds_read_b64_tr_b16 v[172:173], v17 offset:6272
  ds_read_b64_tr_b16 v[174:175], v17 offset:7040
  s_waitcnt lgkmcnt(7)
  v_mfma_f32_32x32x16_bf16 v[64:79], v[148:151], v[144:147], v[64:79]
  ds_read_b128 v[176:179], v15
  ds_read_b64_tr_b16 v[180:181], v17 offset:9216
  ds_read_b64_tr_b16 v[182:183], v17 offset:9984
  v_mfma_f32_32x32x16_bf16 v[80:95], v[152:155], v[144:147], v[80:95]
  ds_read_b64_tr_b16 v[184:185], v17 offset:9280
  ds_read_b64_tr_b16 v[186:187], v17 offset:10048
  v_mfma_f32_32x32x16_bf16 v[96:111], v[144:147], v[156:159], v[96:111]
  ds_read_b64_tr_b16 v[188:189], v17 offset:9344
  ds_read_b64_tr_b16 v[190:191], v17 offset:10112
  v_add_u32 v12, s57, v12
  v_add_u32 v13, s57, v13
  v_add_u32 v14, s57, v14
  v_add_u32 v15, s57, v15
  v_add_u32 v17, s57, v17
  s_barrier
  s_waitcnt lgkmcnt(7)
  v_mfma_f32_32x32x16_bf16 v[64:79], v[164:167], v[160:163], v[64:79]
  ds_read_b128 v[128:131], v12
  ds_read_b64_tr_b16 v[132:133], v17 offset:0
  ds_read_b64_tr_b16 v[134:135], v17 offset:768
  v_mfma_f32_32x32x16_bf16 v[80:95], v[168:171], v[160:163], v[80:95]
  ds_read_b64_tr_b16 v[136:137], v17 offset:64
  ds_read_b64_tr_b16 v[138:139], v17 offset:832
  v_mfma_f32_32x32x16_bf16 v[96:111], v[160:163], v[172:175], v[96:111]
  ds_read_b64_tr_b16 v[140:141], v17 offset:128
  ds_read_b64_tr_b16 v[142:143], v17 offset:896
  s_waitcnt lgkmcnt(7)
  v_mfma_f32_32x32x16_bf16 v[64:79], v[180:183], v[176:179], v[64:79]
  ds_read_b128 v[144:147], v13
  ds_read_b64_tr_b16 v[148:149], v17 offset:3072
  ds_read_b64_tr_b16 v[150:151], v17 offset:3840
  v_mfma_f32_32x32x16_bf16 v[80:95], v[184:187], v[176:179], v[80:95]
  ds_read_b64_tr_b16 v[152:153], v17 offset:3136
  ds_read_b64_tr_b16 v[154:155], v17 offset:3904
  v_mfma_f32_32x32x16_bf16 v[96:111], v[176:179], v[188:191], v[96:111]
  ds_read_b64_tr_b16 v[156:157], v17 offset:3200
  ds_read_b64_tr_b16 v[158:159], v17 offset:3968
  s_waitcnt lgkmcnt(7)
  v_mfma_f32_32x32x16_bf16 v[64:79], v[132:135], v[128:131], v[64:79]
  ds_read_b128 v[160:163], v14
  ds_read_b64_tr_b16 v[164:165], v17 offset:6144
  ds_read_b64_tr_b16 v[166:167], v17 offset:6912
  v_mfma_f32_32x32x16_bf16 v[80:95], v[136:139], v[128:131], v[80:95]
  ds_read_b64_tr_b16 v[168:169], v17 offset:6208
  ds_read_b64_tr_b16 v[170:171], v17 offset:6976
  v_mfma_f32_32x32x16_bf16 v[96:111], v[128:131], v[140:143], v[96:111]
  ds_read_b64_tr_b16 v[172:173], v17 offset:6272
  ds_read_b64_tr_b16 v[174:175], v17 offset:7040
  s_waitcnt lgkmcnt(7)
  v_mfma_f32_32x32x16_bf16 v[64:79], v[148:151], v[144:147], v[64:79]
  ds_read_b128 v[176:179], v15
  ds_read_b64_tr_b16 v[180:181], v17 offset:9216
  ds_read_b64_tr_b16 v[182:183], v17 offset:9984
  v_mfma_f32_32x32x16_bf16 v[80:95], v[152:155], v[144:147], v[80:95]
  ds_read_b64_tr_b16 v[184:185], v17 offset:9280
  ds_read_b64_tr_b16 v[186:187], v17 offset:10048
  v_mfma_f32_32x32x16_bf16 v[96:111], v[144:147], v[156:159], v[96:111]
  ds_read_b64_tr_b16 v[188:189], v17 offset:9344
  ds_read_b64_tr_b16 v[190:191], v17 offset:10112
  v_add_u32 v12, s56, v12
  v_add_u32 v13, s56, v13
  v_add_u32 v14, s56, v14
  v_add_u32 v15, s56, v15
  v_add_u32 v17, s56, v17
  s_barrier
  s_waitcnt lgkmcnt(7)
  v_mfma_f32_32x32x16_bf16 v[64:79], v[164:167], v[160:163], v[64:79]
  ds_read_b128 v[128:131], v12
  ds_read_b64_tr_b16 v[132:133], v17 offset:0
  ds_read_b64_tr_b16 v[134:135], v17 offset:768
  v_mfma_f32_32x32x16_bf16 v[80:95], v[168:171], v[160:163], v[80:95]
  ds_read_b64_tr_b16 v[136:137], v17 offset:64
  ds_read_b64_tr_b16 v[138:139], v17 offset:832
  v_mfma_f32_32x32x16_bf16 v[96:111], v[160:163], v[172:175], v[96:111]
  ds_read_b64_tr_b16 v[140:141], v17 offset:128
  ds_read_b64_tr_b16 v[142:143], v17 offset:896
  s_waitcnt lgkmcnt(7)
  v_mfma_f32_32x32x16_bf16 v[64:79], v[180:183], v[176:179], v[64:79]
  ds_read_b128 v[144:147], v13
  ds_read_b64_tr_b16 v[148:149], v17 offset:3072
  ds_read_b64_tr_b16 v[150:151], v17 offset:3840
  v_mfma_f32_32x32x16_bf16 v[80:95], v[184:187], v[176:179], v[80:95]
  ds_read_b64_tr_b16 v[152:153], v17 offset:3136
  ds_read_b64_tr_b16 v[154:155], v17 offset:3904
  v_mfma_f32_32x32x16_bf16 v[96:111], v[176:179], v[188:191], v[96:111]
  ds_read_b64_tr_b16 v[156:157], v17 offset:3200
  ds_read_b64_tr_b16 v[158:159], v17 offset:3968
  s_waitcnt lgkmcnt(7)
  v_mfma_f32_32x32x16_bf16 v[64:79], v[132:135], v[128:131], v[64:79]
  ds_read_b128 v[160:163], v14
  ds_read_b64_tr_b16 v[164:165], v17 offset:6144
  ds_read_b64_tr_b16 v[166:167], v17 offset:6912
  v_mfma_f32_32x32x16_bf16 v[80:95], v[136:139], v[128:131], v[80:95]
  ds_read_b64_tr_b16 v[168:169], v17 offset:6208
  ds_read_b64_tr_b16 v[170:171], v17 offset:6976
  v_mfma_f32_32x32x16_bf16 v[96:111], v[128:131], v[140:143], v[96:111]
  ds_read_b64_tr_b16 v[172:173], v17 offset:6272
  ds_read_b64_tr_b16 v[174:175], v17 offset:7040
  s_waitcnt lgkmcnt(7)
  v_mfma_f32_32x32x16_bf16 v[64:79], v[148:151], v[144:147], v[64:79]
  ds_read_b128 v[176:179], v15
  ds_read_b64_tr_b16 v[180:181], v17 offset:9216
  ds_read_b64_tr_b16 v[182:183], v17 offset:9984
  v_mfma_f32_32x32x16_bf16 v[80:95], v[152:155], v[144:147], v[80:95]
  ds_read_b64_tr_b16 v[184:185], v17 offset:9280
  ds_read_b64_tr_b16 v[186:187], v17 offset:10048
  v_mfma_f32_32x32x16_bf16 v[96:111], v[144:147], v[156:159], v[96:111]
  ds_read_b64_tr_b16 v[188:189], v17 offset:9344
  ds_read_b64_tr_b16 v[190:191], v17 offset:10112
  v_add_u32 v12, s57, v12
  v_add_u32 v13, s57, v13
  v_add_u32 v14, s57, v14
  v_add_u32 v15, s57, v15
  v_add_u32 v17, s57, v17
  s_barrier
  s_waitcnt lgkmcnt(7)
  v_mfma_f32_32x32x16_bf16 v[64:79], v[164:167], v[160:163], v[64:79]
  ds_read_b128 v[128:131], v12
  ds_read_b64_tr_b16 v[132:133], v17 offset:0
  ds_read_b64_tr_b16 v[134:135], v17 offset:768
  v_mfma_f32_32x32x16_bf16 v[80:95], v[168:171], v[160:163], v[80:95]
  ds_read_b64_tr_b16 v[136:137], v17 offset:64
  ds_read_b64_tr_b16 v[138:139], v17 offset:832
  v_mfma_f32_32x32x16_bf16 v[96:111], v[160:163], v[172:175], v[96:111]
  ds_read_b64_tr_b16 v[140:141], v17 offset:128
  ds_read_b64_tr_b16 v[142:143], v17 offset:896
  s_waitcnt lgkmcnt(7)
  v_mfma_f32_32x32x16_bf16 v[64:79], v[180:183], v[176:179], v[64:79]
  ds_read_b128 v[144:147], v13
  ds_read_b64_tr_b16 v[148:149], v17 offset:3072
  ds_read_b64_tr_b16 v[150:151], v17 offset:3840
  v_mfma_f32_32x32x16_bf16 v[80:95], v[184:187], v[176:179], v[80:95]
  ds_read_b64_tr_b16 v[152:153], v17 offset:3136
  ds_read_b64_tr_b16 v[154:155], v17 offset:3904
  v_mfma_f32_32x32x16_bf16 v[96:111], v[176:179], v[188:191], v[96:111]
  ds_read_b64_tr_b16 v[156:157], v17 offset:3200
  ds_read_b64_tr_b16 v[158:159], v17 offset:3968
  s_waitcnt lgkmcnt(7)
  v_mfma_f32_32x32x16_bf16 v[64:79], v[132:135], v[128:131], v[64:79]
  ds_read_b128 v[160:163], v14
  ds_read_b64_tr_b16 v[164:165], v17 offset:6144
  ds_read_b64_tr_b16 v[166:167], v17 offset:6912
  v_mfma_f32_32x32x16_bf16 v[80:95], v[136:139], v[128:131], v[80:95]
  ds_read_b64_tr_b16 v[168:169], v17 offset:6208
  ds_read_b64_tr_b16 v[170:171], v17 offset:6976
  v_mfma_f32_32x32x16_bf16 v[96:111], v[128:131], v[140:143], v[96:111]
  ds_read_b64_tr_b16 v[172:173], v17 offset:6272
  ds_read_b64_tr_b16 v[174:175], v17 offset:7040
  s_waitcnt lgkmcnt(7)
  v_mfma_f32_32x32x16_bf16 v[64:79], v[148:151], v[144:147], v[64:79]
  ds_read_b128 v[176:179], v15
  ds_read_b64_tr_b16 v[180:181], v17 offset:9216
  ds_read_b64_tr_b16 v[182:183], v17 offset:9984
  v_mfma_f32_32x32x16_bf16 v[80:95], v[152:155], v[144:147], v[80:95]
  ds_read_b64_tr_b16 v[184:185], v17 offset:9280
  ds_read_b64_tr_b16 v[186:187], v17 offset:10048
  v_mfma_f32_32x32x16_bf16 v[96:111], v[144:147], v[156:159], v[96:111]
  ds_read_b64_tr_b16 v[188:189], v17 offset:9344
  ds_read_b64_tr_b16 v[190:191], v17 offset:10112
  v_add_u32 v12, s57, v12
  v_add_u32 v13, s57, v13
  v_add_u32 v14, s57, v14
  v_add_u32 v15, s57, v15
  v_add_u32 v17, s57, v17
  s_barrier
  s_waitcnt lgkmcnt(7)
  v_mfma_f32_32x32x16_bf16 v[64:79], v[164:167], v[160:163], v[64:79]
  ds_read_b128 v[128:131], v12
  ds_read_b64_tr_b16 v[132:133], v17 offset:0
  ds_read_b64_tr_b16 v[134:135], v17 offset:768
  v_mfma_f32_32x32x16_bf16 v[80:95], v[168:171], v[160:163], v[80:95]
  ds_read_b64_tr_b16 v[136:137], v17 offset:64
  ds_read_b64_tr_b16 v[138:139], v17 offset:832
  v_mfma_f32_32x32x16_bf16 v[96:111], v[160:163], v[172:175], v[96:111]
  ds_read_b64_tr_b16 v[140:141], v17 offset:128
  ds_read_b64_tr_b16 v[142:143], v17 offset:896
  s_waitcnt lgkmcnt(7)
  v_mfma_f32_32x32x16_bf16 v[64:79], v[180:183], v[176:179], v[64:79]
  ds_read_b128 v[144:147], v13
  ds_read_b64_tr_b16 v[148:149], v17 offset:3072
  ds_read_b64_tr_b16 v[150:151], v17 offset:3840
  v_mfma_f32_32x32x16_bf16 v[80:95], v[184:187], v[176:179], v[80:95]
  ds_read_b64_tr_b16 v[152:153], v17 offset:3136
  ds_read_b64_tr_b16 v[154:155], v17 offset:3904
  v_mfma_f32_32x32x16_bf16 v[96:111], v[176:179], v[188:191], v[96:111]
  ds_read_b64_tr_b16 v[156:157], v17 offset:3200
  ds_read_b64_tr_b16 v[158:159], v17 offset:3968
  s_waitcnt lgkmcnt(7)
  v_mfma_f32_32x32x16_bf16 v[64:79], v[132:135], v[128:131], v[64:79]
  ds_read_b128 v[160:163], v14
  ds_read_b64_tr_b16 v[164:165], v17 offset:6144
  ds_read_b64_tr_b16 v[166:167], v17 offset:6912
  v_mfma_f32_32x32x16_bf16 v[80:95], v[136:139], v[128:131], v[80:95]
  ds_read_b64_tr_b16 v[168:169], v17 offset:6208
  ds_read_b64_tr_b16 v[170:171], v17 offset:6976
  v_mfma_f32_32x32x16_bf16 v[96:111], v[128:131], v[140:143], v[96:111]
  ds_read_b64_tr_b16 v[172:173], v17 offset:6272
  ds_read_b64_tr_b16 v[174:175], v17 offset:7040
  s_waitcnt lgkmcnt(7)
  v_mfma_f32_32x32x16_bf16 v[64:79], v[148:151], v[144:147], v[64:79]
  ds_read_b128 v[176:179], v15
  ds_read_b64_tr_b16 v[180:181], v17 offset:9216
  ds_read_b64_tr_b16 v[182:183], v17 offset:9984
  v_mfma_f32_32x32x16_bf16 v[80:95], v[152:155], v[144:147], v[80:95]
  ds_read_b64_tr_b16 v[184:185], v17 offset:9280
  ds_read_b64_tr_b16 v[186:187], v17 offset:10048
  v_mfma_f32_32x32x16_bf16 v[96:111], v[144:147], v[156:159], v[96:111]
  ds_read_b64_tr_b16 v[188:189], v17 offset:9344
  ds_read_b64_tr_b16 v[190:191], v17 offset:10112
  s_waitcnt lgkmcnt(7)
  v_mfma_f32_32x32x16_bf16 v[64:79], v[164:167], v[160:163], v[64:79]
  v_mfma_f32_32x32x16_bf16 v[80:95], v[168:171], v[160:163], v[80:95]
  v_mfma_f32_32x32x16_bf16 v[96:111], v[160:163], v[172:175], v[96:111]
  s_waitcnt lgkmcnt(0)
  v_mfma_f32_32x32x16_bf16 v[64:79], v[180:183], v[176:179], v[64:79]
  v_mfma_f32_32x32x16_bf16 v[80:95], v[184:187], v[176:179], v[80:95]
  v_mfma_f32_32x32x16_bf16 v[96:111], v[176:179], v[188:191], v[96:111]
  s_barrier
  s_setprio 3
  ds_read_b32 v21, v20
  ds_read_b32 v22, v20 offset:512
  ds_read_b128 v[144:147], v24 offset:128
  ds_read_b128 v[148:151], v24 offset:160
  ds_read_b128 v[152:155], v24 offset:192
  ds_read_b128 v[156:159], v24 offset:224
  ds_read_b32 v26, v25
  ds_read_b128 v[176:179], v27 offset:512
  ds_read_b128 v[180:183], v27 offset:544
  ds_read_b128 v[184:187], v27 offset:576
  ds_read_b128 v[188:191], v27 offset:608
  ds_read_b128 v[160:163], v27 offset:0
  ds_read_b128 v[164:167], v27 offset:32
  ds_read_b128 v[168:171], v27 offset:64
  ds_read_b128 v[172:175], v27 offset:96
  s_waitcnt lgkmcnt(13)
  v_mul_f32 v38, v21, v22
  v_mul_f32 v34, 0x3eb8aa3b, v21
  v_sub_f32 v38, 0, v38
  v_mul_f32 v36, 0x3eb8aa3b, v38
  s_waitcnt lgkmcnt(9)
  v_mul_f32 v144, v38, v144
  v_mul_f32 v145, v38, v145
  v_mul_f32 v146, v38, v146
  v_mul_f32 v147, v38, v147
  v_mul_f32 v148, v38, v148
  v_mul_f32 v149, v38, v149
  v_mul_f32 v150, v38, v150
  v_mul_f32 v151, v38, v151
  v_mul_f32 v152, v38, v152
  v_mul_f32 v153, v38, v153
  v_mul_f32 v154, v38, v154
  v_mul_f32 v155, v38, v155
  v_mul_f32 v156, v38, v156
  v_mul_f32 v157, v38, v157
  v_mul_f32 v158, v38, v158
  v_mul_f32 v159, v38, v159
  v_fmac_f32 v144, v21, v80
  v_fmac_f32 v145, v21, v81
  v_fmac_f32 v146, v21, v82
  v_fmac_f32 v147, v21, v83
  v_fmac_f32 v148, v21, v84
  v_fmac_f32 v149, v21, v85
  v_fmac_f32 v150, v21, v86
  v_fmac_f32 v151, v21, v87
  v_fmac_f32 v152, v21, v88
  v_fmac_f32 v153, v21, v89
  v_fmac_f32 v154, v21, v90
  v_fmac_f32 v155, v21, v91
  v_fmac_f32 v156, v21, v92
  v_fmac_f32 v157, v21, v93
  v_fmac_f32 v158, v21, v94
  v_fmac_f32 v159, v21, v95
  v_cvt_pk_bf16_f32 v80, v144, v145
  v_cvt_pk_bf16_f32 v81, v146, v147
  v_cvt_pk_bf16_f32 v82, v148, v149
  v_cvt_pk_bf16_f32 v83, v150, v151
  v_cvt_pk_bf16_f32 v84, v152, v153
  v_cvt_pk_bf16_f32 v85, v154, v155
  v_cvt_pk_bf16_f32 v86, v156, v157
  v_cvt_pk_bf16_f32 v87, v158, v159
  buffer_store_dwordx4 v[80:83], v29, s[28:31], s52 offen sc1
  buffer_store_dwordx4 v[84:87], v29, s[28:31], s53 offen sc1
  ds_read_b128 v[128:131], v24 offset:0
  ds_read_b128 v[132:135], v24 offset:32
  ds_read_b128 v[136:139], v24 offset:64
  ds_read_b128 v[140:143], v24 offset:96
  s_waitcnt lgkmcnt(8)
  v_sub_f32 v26, 0, v26
  s_waitcnt lgkmcnt(4)
  v_fmac_f32 v96, v26, v176
  v_fmac_f32 v97, v26, v177
  v_fmac_f32 v98, v26, v178
  v_fmac_f32 v99, v26, v179
  v_fmac_f32 v100, v26, v180
  v_fmac_f32 v101, v26, v181
  v_fmac_f32 v102, v26, v182
  v_fmac_f32 v103, v26, v183
  v_fmac_f32 v104, v26, v184
  v_fmac_f32 v105, v26, v185
  v_fmac_f32 v106, v26, v186
  v_fmac_f32 v107, v26, v187
  v_fmac_f32 v108, v26, v188
  v_fmac_f32 v109, v26, v189
  v_fmac_f32 v110, v26, v190
  v_fmac_f32 v111, v26, v191
  v_mul_f32 v96, v96, v160
  v_mul_f32 v97, v97, v161
  v_mul_f32 v98, v98, v162
  v_mul_f32 v99, v99, v163
  v_mul_f32 v100, v100, v164
  v_mul_f32 v101, v101, v165
  v_mul_f32 v102, v102, v166
  v_mul_f32 v103, v103, v167
  v_mul_f32 v104, v104, v168
  v_mul_f32 v105, v105, v169
  v_mul_f32 v106, v106, v170
  v_mul_f32 v107, v107, v171
  v_mul_f32 v108, v108, v172
  v_mul_f32 v109, v109, v173
  v_mul_f32 v110, v110, v174
  v_mul_f32 v111, v111, v175
  v_cvt_pk_bf16_f32 v160, v96, v97
  v_cvt_pk_bf16_f32 v161, v98, v99
  v_cvt_pk_bf16_f32 v162, v100, v101
  v_cvt_pk_bf16_f32 v163, v102, v103
  v_cvt_pk_bf16_f32 v164, v104, v105
  v_cvt_pk_bf16_f32 v165, v106, v107
  v_cvt_pk_bf16_f32 v166, v108, v109
  v_cvt_pk_bf16_f32 v167, v110, v111
  buffer_store_dwordx4 v[160:163], v30, s[28:31], s54 offen sc1
  buffer_store_dwordx4 v[164:167], v30, s[28:31], s54 offen offset:512 sc1
  s_waitcnt lgkmcnt(0)
  v_mul_f32 v128, v36, v128
  v_mul_f32 v129, v36, v129
  v_mul_f32 v130, v36, v130
  v_mul_f32 v131, v36, v131
  v_mul_f32 v132, v36, v132
  v_mul_f32 v133, v36, v133
  v_mul_f32 v134, v36, v134
  v_mul_f32 v135, v36, v135
  v_mul_f32 v136, v36, v136
  v_mul_f32 v137, v36, v137
  v_mul_f32 v138, v36, v138
  v_mul_f32 v139, v36, v139
  v_mul_f32 v140, v36, v140
  v_mul_f32 v141, v36, v141
  v_mul_f32 v142, v36, v142
  v_mul_f32 v143, v36, v143
  v_fmac_f32 v128, v34, v64
  v_fmac_f32 v129, v34, v65
  v_fmac_f32 v130, v34, v66
  v_fmac_f32 v131, v34, v67
  v_fmac_f32 v132, v34, v68
  v_fmac_f32 v133, v34, v69
  v_fmac_f32 v134, v34, v70
  v_fmac_f32 v135, v34, v71
  v_fmac_f32 v136, v34, v72
  v_fmac_f32 v137, v34, v73
  v_fmac_f32 v138, v34, v74
  v_fmac_f32 v139, v34, v75
  v_fmac_f32 v140, v34, v76
  v_fmac_f32 v141, v34, v77
  v_fmac_f32 v142, v34, v78
  v_fmac_f32 v143, v34, v79
  v_cvt_pk_bf16_f32 v64, v128, v129
  v_cvt_pk_bf16_f32 v65, v130, v131
  v_cvt_pk_bf16_f32 v66, v132, v133
  v_cvt_pk_bf16_f32 v67, v134, v135
  v_cvt_pk_bf16_f32 v68, v136, v137
  v_cvt_pk_bf16_f32 v69, v138, v139
  v_cvt_pk_bf16_f32 v70, v140, v141
  v_cvt_pk_bf16_f32 v71, v142, v143
  buffer_store_dwordx4 v[64:67], v28, s[28:31], s50 offen sc1
  buffer_store_dwordx4 v[68:71], v28, s[28:31], s51 offen sc1
  v_mul_f32 v42, v144, v144
  v_mul_f32 v43, v152, v152
  v_fmac_f32 v42, v145, v145
  v_fmac_f32 v43, v153, v153
  v_fmac_f32 v42, v146, v146
  v_fmac_f32 v43, v154, v154
  v_fmac_f32 v42, v147, v147
  v_fmac_f32 v43, v155, v155
  v_fmac_f32 v42, v148, v148
  v_fmac_f32 v43, v156, v156
  v_fmac_f32 v42, v149, v149
  v_fmac_f32 v43, v157, v157
  v_fmac_f32 v42, v150, v150
  v_fmac_f32 v43, v158, v158
  v_fmac_f32 v42, v151, v151
  v_fmac_f32 v43, v159, v159
  v_mul_f32 v46, v128, v128
  v_mul_f32 v47, v136, v136
  v_fmac_f32 v46, v129, v129
  v_fmac_f32 v47, v137, v137
  v_fmac_f32 v46, v130, v130
  v_fmac_f32 v47, v138, v138
  v_fmac_f32 v46, v131, v131
  v_fmac_f32 v47, v139, v139
  v_fmac_f32 v46, v132, v132
  v_fmac_f32 v47, v140, v140
  v_fmac_f32 v46, v133, v133
  v_fmac_f32 v47, v141, v141
  v_fmac_f32 v46, v134, v134
  v_fmac_f32 v47, v142, v142
  v_fmac_f32 v46, v135, v135
  v_fmac_f32 v47, v143, v143
  v_max3_f32 v38, |v96|, |v97|, |v98|
  v_max_f32 v34, v42, v43
  v_max_f32 v35, v46, v47
  v_max3_f32 v38, v38, |v99|, |v100|
  v_max3_f32 v38, v38, |v101|, |v102|
  v_max3_f32 v38, v38, |v103|, |v104|
  v_max3_f32 v38, v38, |v105|, |v106|
  v_max3_f32 v38, v38, |v107|, |v108|
  v_max3_f32 v38, v38, |v109|, |v110|
  v_max_f32 v36, v38, |v111|
  s_nop 1
  v_max_f32_dpp v34, v34, v34 row_shr:1 row_mask:0xf bank_mask:0xf
  v_max_f32_dpp v35, v35, v35 row_shr:1 row_mask:0xf bank_mask:0xf
  v_max_f32_dpp v36, v36, v36 row_shr:1 row_mask:0xf bank_mask:0xf
  v_max_f32_dpp v34, v34, v34 row_shr:2 row_mask:0xf bank_mask:0xf
  v_max_f32_dpp v35, v35, v35 row_shr:2 row_mask:0xf bank_mask:0xf
  v_max_f32_dpp v36, v36, v36 row_shr:2 row_mask:0xf bank_mask:0xf
  v_max_f32_dpp v34, v34, v34 row_shr:4 row_mask:0xf bank_mask:0xf
  v_max_f32_dpp v35, v35, v35 row_shr:4 row_mask:0xf bank_mask:0xf
  v_max_f32_dpp v36, v36, v36 row_shr:4 row_mask:0xf bank_mask:0xf
  v_max_f32_dpp v34, v34, v34 row_shr:8 row_mask:0xf bank_mask:0xf
  v_max_f32_dpp v35, v35, v35 row_shr:8 row_mask:0xf bank_mask:0xf
  v_max_f32_dpp v36, v36, v36 row_shr:8 row_mask:0xf bank_mask:0xf
  v_max_f32_dpp v34, v34, v34 row_bcast:15 row_mask:0xa bank_mask:0xf
  v_max_f32_dpp v35, v35, v35 row_bcast:15 row_mask:0xa bank_mask:0xf
  v_max_f32_dpp v36, v36, v36 row_bcast:15 row_mask:0xa bank_mask:0xf
  s_nop 1
  v_mov_b32 v40, v34
  v_mov_b32 v41, v35
  v_mov_b32 v42, v36
  s_nop 1
  v_permlane32_swap_b32 v34, v40
  v_permlane32_swap_b32 v35, v41
  v_permlane32_swap_b32 v36, v42
  s_nop 1
  v_add_f32 v34, v34, v40
  v_add_f32 v35, v35, v41
  v_max_f32 v36, v36, v42
  v_mov_b32 v40, 159792
  s_mov_b32 s66, 0x80000000
  s_mov_b32 s67, 0
  s_mov_b64 exec, s[66:67]
  ds_max_u32 v40, v34
  ds_max_u32 v40, v35 offset:4
  ds_max_u32 v40, v36 offset:8
  s_mov_b64 exec, -1
  s_setprio 0
  s_lshl_b32 s48, s39, 4
  s_add_u32 s48, s48, s38
  s_lshl_b32 s48, s48, 7
  s_add_u32 s48, s48, 32768
  v_mov_b32 v44, 159744
  v_mov_b32 v45, 1
  s_waitcnt vmcnt(0) lgkmcnt(0)
  s_mov_b64 exec, 1
  ds_add_rtn_u32 v46, v44, v45
  ds_read_b128 v[48:51], v40
  s_waitcnt lgkmcnt(0)
  v_readfirstlane_b32 s66, v46
  v_add_u32 v48, 0xffff, v48
  v_add_u32 v49, 0xffff, v49
  v_lshrrev_b32 v48, 16, v48
  v_and_b32 v49, 0xffff0000, v49
  v_or_b32 v54, v48, v49
  v_mov_b32 v55, v50
  v_mov_b32 v52, s64
  v_mov_b32 v53, s65
  v_mov_b32 v46, 0
  s_cmp_eq_u32 s66, 3
  s_cbranch_scc0 SIG1_1
  buffer_store_dwordx4 v[52:55], v46, s[28:31], s48 offen sc1
SIG1_1:
  s_mov_b64 exec, -1
K_ATT:
  s_setprio 1
  s_and_b32 s48, s2, 7
  s_lshr_b32 s49, s2, 3
  s_and_b32 s50, s49, 3
  s_lshl_b32 s48, s48, 2
  s_add_u32 s38, s48, s50
  s_lshr_b32 s39, s49, 2
  v_lshlrev_b32 v5, 4, v1
  v_lshlrev_b32 v6, 8, v4
  v_and_b32 v7, 15, v1
  v_lshlrev_b32 v7, 4, v7
  v_add_u32 v6, v6, v7
  v_lshlrev_b32 v8, 7, v1
  v_lshlrev_b32 v9, 2, v1
  s_lshl_b32 s44, s38, 16
  s_lshl_b32 s46, s39, 13
  s_add_u32 s46, s46, s44
  s_add_u32 s46, s46, 1048576
  s_lshl_b32 s47, s36, 14
  s_add_u32 s47, s47, s44
  s_add_u32 s48, s47, 5242880
  s_add_u32 s47, s47, 3145728
  s_mov_b32 s40, s47
  s_mov_b32 s41, s48
  s_lshr_b32 s49, s38, 1
  s_mul_i32 s49, s49, 1536
  s_add_u32 s49, s49, 262144
  s_mov_b32 s50, 0x0000ffff
  s_mov_b32 s51, 0x0000ffff
  v_and_b32 v12, 27, v3
  v_cmp_eq_u32 vcc, 16, v12
  v_mov_b32 v12, 0x3f803f80
  s_nop 0
  v_cndmask_b32 v44, 0, v12, vcc
  v_mov_b32 v96, v44
  v_mov_b32 v97, v44
  v_mov_b32 v98, v44
  v_mov_b32 v99, v44
  v_mov_b32 v100, v44
  v_mov_b32 v101, v44
  v_mov_b32 v102, v44
  v_mov_b32 v103, v44
  v_mov_b32 v104, v44
  v_mov_b32 v105, v44
  v_mov_b32 v106, v44
  v_mov_b32 v107, v44
  v_mov_b32 v108, v44
  v_mov_b32 v109, v44
  v_mov_b32 v110, v44
  v_mov_b32 v111, v44
  v_mov_b32 v112, v44
  v_mov_b32 v113, v44
  v_mov_b32 v114, v44
  v_mov_b32 v115, v44
  v_mov_b32 v116, v44
  v_mov_b32 v117, v44
  v_mov_b32 v118, v44
  v_mov_b32 v119, v44
  v_mov_b32 v120, v44
  v_mov_b32 v121, v44
  v_mov_b32 v122, v44
  v_mov_b32 v123, v44
  v_mov_b32 v124, v44
  v_mov_b32 v125, v44
  v_mov_b32 v126, v44
  v_mov_b32 v127, v44
  v_mov_b32 v44, 0xdddddddd
  v_mov_b32 v128, 0
  v_mov_b32 v129, 0
  v_mov_b32 v130, 0
  v_mov_b32 v131, 0
  v_mov_b32 v132, 0
  v_mov_b32 v133, 0
  v_mov_b32 v134, 0
  v_mov_b32 v135, 0
  v_mov_b32 v136, 0
  v_mov_b32 v137, 0
  v_mov_b32 v138, 0
  v_mov_b32 v139, 0
  v_mov_b32 v140, 0
  v_mov_b32 v141, 0
  v_mov_b32 v142, 0
  v_mov_b32 v143, 0
  v_mov_b32 v144, 0
  v_mov_b32 v145, 0
  v_mov_b32 v146, 0
  v_mov_b32 v147, 0
  v_mov_b32 v148, 0
  v_mov_b32 v149, 0
  v_mov_b32 v150, 0
  v_mov_b32 v151, 0
  v_mov_b32 v152, 0
  v_mov_b32 v153, 0
  v_mov_b32 v154, 0
  v_mov_b32 v155, 0
  v_mov_b32 v156, 0
  v_mov_b32 v157, 0
  v_mov_b32 v158, 0
  v_mov_b32 v159, 0
  v_mov_b32 v160, 0
  v_mov_b32 v161, 0
  v_mov_b32 v162, 0
  v_mov_b32 v163, 0
  v_mov_b32 v164, 0
  v_mov_b32 v165, 0
  v_mov_b32 v166, 0
  v_mov_b32 v167, 0
  v_mov_b32 v168, 0
  v_mov_b32 v169, 0
  v_mov_b32 v170, 0
  v_mov_b32 v171, 0
  v_mov_b32 v172, 0
  v_mov_b32 v173, 0
  v_mov_b32 v174, 0
  v_mov_b32 v175, 0
  v_mov_b32 v176, 0
  v_mov_b32 v177, 0
  v_mov_b32 v178, 0
  v_mov_b32 v179, 0
  v_mov_b32 v180, 0
  v_mov_b32 v181, 0
  v_mov_b32 v182, 0
  v_mov_b32 v183, 0
  v_mov_b32 v184, 0
  v_mov_b32 v185, 0
  v_mov_b32 v186, 0
  v_mov_b32 v187, 0
  v_mov_b32 v188, 0
  v_mov_b32 v189, 0
  v_mov_b32 v190, 0
  v_mov_b32 v191, 0
  v_mov_b32 v192, 0
  v_mov_b32 v193, 0
  v_mov_b32 v194, 0
  v_mov_b32 v195, 0
  v_mov_b32 v196, 0
  v_mov_b32 v197, 0
  v_mov_b32 v198, 0
  v_mov_b32 v199, 0
  v_mov_b32 v200, 0
  v_mov_b32 v201, 0
  v_mov_b32 v202, 0
  v_mov_b32 v203, 0
  v_mov_b32 v204, 0
  v_mov_b32 v205, 0
  v_mov_b32 v206, 0
  v_mov_b32 v207, 0
  v_mov_b32 v208, 0
  v_mov_b32 v209, 0
  v_mov_b32 v210, 0
  v_mov_b32 v211, 0
  v_mov_b32 v212, 0
  v_mov_b32 v213, 0
  v_mov_b32 v214, 0
  v_mov_b32 v215, 0
  v_mov_b32 v216, 0
  v_mov_b32 v217, 0
  v_mov_b32 v218, 0
  v_mov_b32 v219, 0
  v_mov_b32 v220, 0
  v_mov_b32 v221, 0
  v_mov_b32 v222, 0
  v_mov_b32 v223, 0
  v_mov_b32 v224, 0
  v_mov_b32 v225, 0
  v_mov_b32 v226, 0
  v_mov_b32 v227, 0
  v_mov_b32 v228, 0
  v_mov_b32 v229, 0
  v_mov_b32 v230, 0
  v_mov_b32 v231, 0
  v_mov_b32 v232, 0
  v_mov_b32 v233, 0
  v_mov_b32 v234, 0
  v_mov_b32 v235, 0
  v_mov_b32 v236, 0
  v_mov_b32 v237, 0
  v_mov_b32 v238, 0
  v_mov_b32 v239, 0
  v_mov_b32 v240, 0
  v_mov_b32 v241, 0
  v_mov_b32 v242, 0
  v_mov_b32 v243, 0
  v_mov_b32 v244, 0
  v_mov_b32 v245, 0
  v_mov_b32 v246, 0
  v_mov_b32 v247, 0
  v_mov_b32 v248, 0
  v_mov_b32 v249, 0
  v_mov_b32 v250, 0
  v_mov_b32 v251, 0
  v_mov_b32 v252, 0
  v_mov_b32 v253, 0
  v_mov_b32 v254, 0
  v_mov_b32 v255, 0
  v_mov_b32 v34, 0
  v_mov_b32 v35, 0
  v_mov_b32 v36, 0
  v_mov_b32 v37, 0
  v_mov_b32 v38, 0
  v_mov_b32 v39, 0
  v_mov_b32 v40, 0
  v_mov_b32 v41, 0
  s_sub_u32 s52, s36, 1
  s_and_b32 s52, s52, 3
  s_mul_i32 s52, s52, 2304
  s_add_u32 s56, s52, 0
  s_sub_u32 s52, s36, 2
  s_and_b32 s52, s52, 3
  s_mul_i32 s52, s52, 2304
  s_add_u32 s57, s52, 13824
  s_sub_u32 s52, s36, 3
  s_and_b32 s52, s52, 3
  s_mul_i32 s52, s52, 2304
  s_add_u32 s58, s52, 27648
  s_sub_u32 s52, s36, 4
  s_and_b32 s52, s52, 3
  s_mul_i32 s52, s52, 2304
  s_add_u32 s59, s52, 41472
  s_lshl_b32 s52, s36, 1
  s_lshl_b32 s52, 3, s52
  s_xor_b32 s45, s52, 0xff
  s_lshr_b32 s52, s38, 1
  s_lshl_b32 s52, s52, 11
  s_add_u32 s52, s52, 32768
  v_mov_b32 v22, 159768
  s_cmp_eq_u32 s36, 0
  s_cbranch_scc0 PWO_24
  s_mov_b32 s66, 0xffff
  s_mov_b32 s67, 0
  s_mov_b32 s68, 1048576
  s_waitcnt vmcnt(0)
  s_mov_b64 exec, s[66:67]
POLL_26:
  buffer_load_dwordx4 v[18:21], v8, s[28:31], s52 offen sc1
  s_waitcnt vmcnt(0)
  v_cmp_eq_u64 vcc, s[64:65], v[18:19]
  s_sub_u32 s68, s68, 1
  s_cmp_eq_u32 s68, 0
  s_cbranch_scc1 POLLD_27
  s_cmp_eq_u64 vcc, s[66:67]
  s_cbranch_scc1 POLLD_27
  s_sleep 2
  s_branch POLL_26
POLLD_27:
  s_mov_b64 exec, -1
  v_mov_b32 v23, 1
  s_mov_b64 exec, 1
  ds_write_b32 v22, v23
  s_mov_b64 exec, -1
  s_waitcnt lgkmcnt(0)
  s_wakeup
  s_branch PWD_25
PWO_24:
PWL_28:
  ds_read_b32 v23, v22
  s_waitcnt lgkmcnt(0)
  v_readfirstlane_b32 s66, v23
  s_nop 0
  s_cmp_eq_u32 s66, 0
  s_cbranch_scc0 PWD_25
  s_sleep 8
  s_branch PWL_28
PWD_25:
  buffer_load_dwordx4 v[80:83], v5, s[28:31], s47 offen sc1
  buffer_load_dwordx4 v[48:51], v5, s[28:31], s46 offen sc1
  s_mov_b64 exec, s[50:51]
  buffer_load_dwordx4 v[96:99], v6, s[28:31], s48 offen sc1
  buffer_load_dwordx4 v[100:103], v6, s[28:31], s48 offen offset:512 sc1
  s_mov_b64 exec, -1
  buffer_load_dwordx4 v[52:55], v5, s[28:31], s46 offen offset:1024 sc1
  buffer_load_dwordx4 v[56:59], v5, s[28:31], s46 offen offset:2048 sc1
  buffer_load_dwordx4 v[60:63], v5, s[28:31], s46 offen offset:3072 sc1
  s_add_u32 s46, s46, 4096
  buffer_load_dwordx4 v[64:67], v5, s[28:31], s46 offen offset:0 sc1
  buffer_load_dwordx4 v[68:71], v5, s[28:31], s46 offen offset:1024 sc1
  buffer_load_dwordx4 v[72:75], v5, s[28:31], s46 offen offset:2048 sc1
  buffer_load_dwordx4 v[76:79], v5, s[28:31], s46 offen offset:3072 sc1
  buffer_load_dwordx4 v[84:87], v5, s[28:31], s47 offen offset:1024 sc1
  s_mov_b64 exec, s[50:51]
  buffer_load_dwordx4 v[104:107], v6, s[28:31], s48 offen offset:1024 sc1
  buffer_load_dwordx4 v[108:111], v6, s[28:31], s48 offen offset:1536 sc1
  s_mov_b64 exec, -1
  buffer_load_dwordx4 v[88:91], v5, s[28:31], s47 offen offset:2048 sc1
  s_mov_b64 exec, s[50:51]
  buffer_load_dwordx4 v[112:115], v6, s[28:31], s48 offen offset:2048 sc1
  buffer_load_dwordx4 v[116:119], v6, s[28:31], s48 offen offset:2560 sc1
  s_mov_b64 exec, -1
  s_cmp_eq_u32 s36, 0
  s_cbranch_scc0 BD_29
  v_lshlrev_b32 v24, 16, v20
  v_and_b32 v25, 0xffff0000, v20
  s_nop 1
  v_max_f32_dpp v24, v24, v24 row_shr:1 row_mask:0xf bank_mask:0xf
  v_max_f32_dpp v25, v25, v25 row_shr:1 row_mask:0xf bank_mask:0xf
  v_max_f32_dpp v21, v21, v21 row_shr:1 row_mask:0xf bank_mask:0xf
  v_max_f32_dpp v24, v24, v24 row_shr:2 row_mask:0xf bank_mask:0xf
  v_max_f32_dpp v25, v25, v25 row_shr:2 row_mask:0xf bank_mask:0xf
  v_max_f32_dpp v21, v21, v21 row_shr:2 row_mask:0xf bank_mask:0xf
  v_max_f32_dpp v24, v24, v24 row_shr:4 row_mask:0xf bank_mask:0xf
  v_max_f32_dpp v25, v25, v25 row_shr:4 row_mask:0xf bank_mask:0xf
  v_max_f32_dpp v21, v21, v21 row_shr:4 row_mask:0xf bank_mask:0xf
  v_max_f32_dpp v24, v24, v24 row_shr:8 row_mask:0xf bank_mask:0xf
  v_max_f32_dpp v25, v25, v25 row_shr:8 row_mask:0xf bank_mask:0xf
  v_max_f32_dpp v21, v21, v21 row_shr:8 row_mask:0xf bank_mask:0xf
  v_mul_f32 v24, v24, v25
  v_mul_f32 v24, 0x3f866666, v24
  v_mov_b32 v25, 0x45100000
  v_cmp_le_f32 vcc, v24, v25
  v_mov_b32 v25, 0x5d800000
  v_cmp_le_f32 s[66:67], v21, v25
  v_mov_b32 v22, 159780
  s_nop 0
  s_and_b64 vcc, vcc, s[66:67]
  s_bitcmp1_b64 vcc, 15
  s_cselect_b32 s66, 1, 2
  v_mov_b32 v23, s66
  s_mov_b64 exec, 1
  ds_write_b32 v22, v23
  s_mov_b64 exec, -1
BD_29:
  s_add_u32 s47, s47, 3072
  s_add_u32 s48, s48, 3072
  s_mov_b32 s42, 0
  s_mov_b32 s43, 0
  s_waitcnt vmcnt(15)
  v_mfma_f32_32x32x16_bf16 v[10:25], v[80:83], v[48:51], 0
  s_nop 7
  s_nop 3
K_ATT_LOOP:
  v_exp_f32 v10, v10
  v_exp_f32 v11, v11
  v_smfmac_f32_32x32x32_bf16 v[240:255], v[124:127], v[34:41], v44
  buffer_load_dwordx4 v[92:95], v5, s[28:31], s47 offen offset:0 sc1
  s_mov_b64 exec, s[50:51]
  buffer_load_dwordx4 v[120:123], v6, s[28:31], s48 offen offset:0 sc1
  buffer_load_dwordx4 v[124:127], v6, s[28:31], s48 offen offset:512 sc1
  s_mov_b64 exec, -1
  v_exp_f32 v12, v12
  v_exp_f32 v13, v13
  v_exp_f32 v14, v14
  s_waitcnt vmcnt(15)
  v_mfma_f32_32x32x16_bf16 v[26:41], v[80:83], v[52:55], 0
  v_exp_f32 v15, v15
  v_exp_f32 v16, v16
  v_exp_f32 v17, v17
  v_exp_f32 v18, v18
  v_exp_f32 v19, v19
  v_exp_f32 v20, v20
  v_smfmac_f32_32x32x32_bf16 v[128:143], v[96:99], v[10:17], v44
  v_exp_f32 v21, v21
  v_exp_f32 v22, v22
  v_exp_f32 v23, v23
  v_exp_f32 v24, v24
  v_exp_f32 v25, v25
  v_exp_f32 v26, v26
  v_exp_f32 v27, v27
  v_smfmac_f32_32x32x32_bf16 v[128:143], v[100:103], v[18:25], v44
  v_exp_f32 v28, v28
  v_exp_f32 v29, v29
  v_exp_f32 v30, v30
  s_waitcnt vmcnt(14)
  v_mfma_f32_32x32x16_bf16 v[10:25], v[80:83], v[56:59], 0
  v_exp_f32 v31, v31
  v_exp_f32 v32, v32
  v_exp_f32 v33, v33
  v_exp_f32 v34, v34
  v_exp_f32 v35, v35
  v_exp_f32 v36, v36
  v_smfmac_f32_32x32x32_bf16 v[144:159], v[96:99], v[26:33], v44
  v_exp_f32 v37, v37
  v_exp_f32 v38, v38
  v_exp_f32 v39, v39
  v_exp_f32 v40, v40
  v_exp_f32 v41, v41
  v_exp_f32 v10, v10
  v_exp_f32 v11, v11
  v_smfmac_f32_32x32x32_bf16 v[144:159], v[100:103], v[34:41], v44
  v_exp_f32 v12, v12
  v_exp_f32 v13, v13
  v_exp_f32 v14, v14
  s_waitcnt vmcnt(13)
  v_mfma_f32_32x32x16_bf16 v[26:41], v[80:83], v[60:63], 0
  v_exp_f32 v15, v15
  v_exp_f32 v16, v16
  v_exp_f32 v17, v17
  v_exp_f32 v18, v18
  v_exp_f32 v19, v19
  v_exp_f32 v20, v20
  v_smfmac_f32_32x32x32_bf16 v[160:175], v[96:99], v[10:17], v44
  v_exp_f32 v21, v21
  v_exp_f32 v22, v22
  v_exp_f32 v23, v23
  v_exp_f32 v24, v24
  v_exp_f32 v25, v25
  v_exp_f32 v26, v26
  v_exp_f32 v27, v27
  v_smfmac_f32_32x32x32_bf16 v[160:175], v[100:103], v[18:25], v44
  v_exp_f32 v28, v28
  v_exp_f32 v29, v29
  v_exp_f32 v30, v30
  s_waitcnt vmcnt(12)
  v_mfma_f32_32x32x16_bf16 v[10:25], v[80:83], v[64:67], 0
  v_exp_f32 v31, v31
  v_exp_f32 v32, v32
  v_exp_f32 v33, v33
  v_exp_f32 v34, v34
  v_exp_f32 v35, v35
  v_exp_f32 v36, v36
  v_smfmac_f32_32x32x32_bf16 v[176:191], v[96:99], v[26:33], v44
  v_exp_f32 v37, v37
  v_exp_f32 v38, v38
  v_exp_f32 v39, v39
  v_exp_f32 v40, v40
  v_exp_f32 v41, v41
  v_exp_f32 v10, v10
  v_exp_f32 v11, v11
  v_smfmac_f32_32x32x32_bf16 v[176:191], v[100:103], v[34:41], v44
  v_exp_f32 v12, v12
  v_exp_f32 v13, v13
  v_exp_f32 v14, v14
  s_waitcnt vmcnt(11)
  v_mfma_f32_32x32x16_bf16 v[26:41], v[80:83], v[68:71], 0
  v_exp_f32 v15, v15
  v_exp_f32 v16, v16
  v_exp_f32 v17, v17
  v_exp_f32 v18, v18
  v_exp_f32 v19, v19
  v_exp_f32 v20, v20
  v_smfmac_f32_32x32x32_bf16 v[192:207], v[96:99], v[10:17], v44
  s_cmp_eq_u32 s42, 3
  s_cbranch_scc1 G2E_30
G2EB_31:
  v_exp_f32 v21, v21
  v_exp_f32 v22, v22
  v_exp_f32 v23, v23
  v_exp_f32 v24, v24
  v_exp_f32 v25, v25
  v_exp_f32 v26, v26
  v_exp_f32 v27, v27
  v_smfmac_f32_32x32x32_bf16 v[192:207], v[100:103], v[18:25], v44
  v_exp_f32 v28, v28
  v_exp_f32 v29, v29
  v_exp_f32 v30, v30
  s_waitcnt vmcnt(10)
  v_mfma_f32_32x32x16_bf16 v[10:25], v[80:83], v[72:75], 0
  v_exp_f32 v31, v31
  v_exp_f32 v32, v32
  v_exp_f32 v33, v33
  v_exp_f32 v34, v34
  v_exp_f32 v35, v35
  v_exp_f32 v36, v36
  v_smfmac_f32_32x32x32_bf16 v[208:223], v[96:99], v[26:33], v44
  v_exp_f32 v37, v37
  v_exp_f32 v38, v38
  v_exp_f32 v39, v39
  v_exp_f32 v40, v40
  v_exp_f32 v41, v41
  v_exp_f32 v10, v10
  v_exp_f32 v11, v11
  v_smfmac_f32_32x32x32_bf16 v[208:223], v[100:103], v[34:41], v44
  v_exp_f32 v12, v12
  v_exp_f32 v13, v13
  v_exp_f32 v14, v14
  s_waitcnt vmcnt(9)
  v_mfma_f32_32x32x16_bf16 v[26:41], v[80:83], v[76:79], 0
  v_exp_f32 v15, v15
  v_exp_f32 v16, v16
  v_exp_f32 v17, v17
  v_exp_f32 v18, v18
  v_exp_f32 v19, v19
  v_exp_f32 v20, v20
  v_smfmac_f32_32x32x32_bf16 v[224:239], v[96:99], v[10:17], v44
  v_exp_f32 v21, v21
  v_exp_f32 v22, v22
  v_exp_f32 v23, v23
  v_exp_f32 v24, v24
  v_exp_f32 v25, v25
  v_exp_f32 v26, v26
  v_exp_f32 v27, v27
  v_smfmac_f32_32x32x32_bf16 v[224:239], v[100:103], v[18:25], v44
  v_exp_f32 v28, v28
  v_exp_f32 v29, v29
  v_exp_f32 v30, v30
  s_waitcnt vmcnt(6)
  v_mfma_f32_32x32x16_bf16 v[10:25], v[84:87], v[48:51], 0
  v_exp_f32 v31, v31
  v_exp_f32 v32, v32
  v_exp_f32 v33, v33
  v_exp_f32 v34, v34
  v_exp_f32 v35, v35
  v_exp_f32 v36, v36
  v_smfmac_f32_32x32x32_bf16 v[240:255], v[96:99], v[26:33], v44
  v_exp_f32 v37, v37
  v_exp_f32 v38, v38
  v_exp_f32 v39, v39
  v_exp_f32 v40, v40
  v_exp_f32 v41, v41
  v_exp_f32 v10, v10
  v_exp_f32 v11, v11
  v_smfmac_f32_32x32x32_bf16 v[240:255], v[100:103], v[34:41], v44
  buffer_load_dwordx4 v[80:83], v5, s[28:31], s47 offen offset:1024 sc1
  s_mov_b64 exec, s[50:51]
  buffer_load_dwordx4 v[96:99], v6, s[28:31], s48 offen offset:1024 sc1
  buffer_load_dwordx4 v[100:103], v6, s[28:31], s48 offen offset:1536 sc1
  s_mov_b64 exec, -1
  v_exp_f32 v12, v12
  v_exp_f32 v13, v13
  v_exp_f32 v14, v14
  v_mfma_f32_32x32x16_bf16 v[26:41], v[84:87], v[52:55], 0
  v_exp_f32 v15, v15
  v_exp_f32 v16, v16
  v_exp_f32 v17, v17
  v_exp_f32 v18, v18
  v_exp_f32 v19, v19
  v_exp_f32 v20, v20
  v_smfmac_f32_32x32x32_bf16 v[128:143], v[104:107], v[10:17], v44
  v_exp_f32 v21, v21
  v_exp_f32 v22, v22
  v_exp_f32 v23, v23
  v_exp_f32 v24, v24
  v_exp_f32 v25, v25
  v_exp_f32 v26, v26
  v_exp_f32 v27, v27
  v_smfmac_f32_32x32x32_bf16 v[128:143], v[108:111], v[18:25], v44
  s_cmp_eq_u32 s42, 0
  s_cbranch_scc1 CHK_32
CHKB_33:
  v_exp_f32 v28, v28
  v_exp_f32 v29, v29
  v_exp_f32 v30, v30
  v_mfma_f32_32x32x16_bf16 v[10:25], v[84:87], v[56:59], 0
  v_exp_f32 v31, v31
  v_exp_f32 v32, v32
  v_exp_f32 v33, v33
  v_exp_f32 v34, v34
  v_exp_f32 v35, v35
  v_exp_f32 v36, v36
  v_smfmac_f32_32x32x32_bf16 v[144:159], v[104:107], v[26:33], v44
  v_exp_f32 v37, v37
  v_exp_f32 v38, v38
  v_exp_f32 v39, v39
  v_exp_f32 v40, v40
  v_exp_f32 v41, v41
  v_exp_f32 v10, v10
  v_exp_f32 v11, v11
  v_smfmac_f32_32x32x32_bf16 v[144:159], v[108:111], v[34:41], v44
  v_exp_f32 v12, v12
  v_exp_f32 v13, v13
  v_exp_f32 v14, v14
  v_mfma_f32_32x32x16_bf16 v[26:41], v[84:87], v[60:63], 0
  v_exp_f32 v15, v15
  v_exp_f32 v16, v16
  v_exp_f32 v17, v17
  v_exp_f32 v18, v18
  v_exp_f32 v19, v19
  v_exp_f32 v20, v20
  v_smfmac_f32_32x32x32_bf16 v[160:175], v[104:107], v[10:17], v44
  v_exp_f32 v21, v21
  v_exp_f32 v22, v22
  v_exp_f32 v23, v23
  v_exp_f32 v24, v24
  v_exp_f32 v25, v25
  v_exp_f32 v26, v26
  v_exp_f32 v27, v27
  v_smfmac_f32_32x32x32_bf16 v[160:175], v[108:111], v[18:25], v44
  v_exp_f32 v28, v28
  v_exp_f32 v29, v29
  v_exp_f32 v30, v30
  v_mfma_f32_32x32x16_bf16 v[10:25], v[84:87], v[64:67], 0
  v_exp_f32 v31, v31
  v_exp_f32 v32, v32
  v_exp_f32 v33, v33
  v_exp_f32 v34, v34
  v_exp_f32 v35, v35
  v_exp_f32 v36, v36
  v_smfmac_f32_32x32x32_bf16 v[176:191], v[104:107], v[26:33], v44
  v_exp_f32 v37, v37
  v_exp_f32 v38, v38
  v_exp_f32 v39, v39
  v_exp_f32 v40, v40
  v_exp_f32 v41, v41
  v_exp_f32 v10, v10
  v_exp_f32 v11, v11
  v_smfmac_f32_32x32x32_bf16 v[176:191], v[108:111], v[34:41], v44
  v_exp_f32 v12, v12
  v_exp_f32 v13, v13
  v_exp_f32 v14, v14
  v_mfma_f32_32x32x16_bf16 v[26:41], v[84:87], v[68:71], 0
  v_exp_f32 v15, v15
  v_exp_f32 v16, v16
  v_exp_f32 v17, v17
  v_exp_f32 v18, v18
  v_exp_f32 v19, v19
  v_exp_f32 v20, v20
  v_smfmac_f32_32x32x32_bf16 v[192:207], v[104:107], v[10:17], v44
  v_exp_f32 v21, v21
  v_exp_f32 v22, v22
  v_exp_f32 v23, v23
  v_exp_f32 v24, v24
  v_exp_f32 v25, v25
  v_exp_f32 v26, v26
  v_exp_f32 v27, v27
  v_smfmac_f32_32x32x32_bf16 v[192:207], v[108:111], v[18:25], v44
  v_exp_f32 v28, v28
  v_exp_f32 v29, v29
  v_exp_f32 v30, v30
  v_mfma_f32_32x32x16_bf16 v[10:25], v[84:87], v[72:75], 0
  v_exp_f32 v31, v31
  v_exp_f32 v32, v32
  v_exp_f32 v33, v33
  v_exp_f32 v34, v34
  v_exp_f32 v35, v35
  v_exp_f32 v36, v36
  v_smfmac_f32_32x32x32_bf16 v[208:223], v[104:107], v[26:33], v44
  v_exp_f32 v37, v37
  v_exp_f32 v38, v38
  v_exp_f32 v39, v39
  v_exp_f32 v40, v40
  v_exp_f32 v41, v41
  v_exp_f32 v10, v10
  v_exp_f32 v11, v11
  v_smfmac_f32_32x32x32_bf16 v[208:223], v[108:111], v[34:41], v44
  v_exp_f32 v12, v12
  v_exp_f32 v13, v13
  v_exp_f32 v14, v14
  v_mfma_f32_32x32x16_bf16 v[26:41], v[84:87], v[76:79], 0
  v_exp_f32 v15, v15
  v_exp_f32 v16, v16
  v_exp_f32 v17, v17
  v_exp_f32 v18, v18
  v_exp_f32 v19, v19
  v_exp_f32 v20, v20
  v_smfmac_f32_32x32x32_bf16 v[224:239], v[104:107], v[10:17], v44
  v_exp_f32 v21, v21
  v_exp_f32 v22, v22
  v_exp_f32 v23, v23
  v_exp_f32 v24, v24
  v_exp_f32 v25, v25
  v_exp_f32 v26, v26
  v_exp_f32 v27, v27
  v_smfmac_f32_32x32x32_bf16 v[224:239], v[108:111], v[18:25], v44
  v_exp_f32 v28, v28
  v_exp_f32 v29, v29
  v_exp_f32 v30, v30
  s_waitcnt vmcnt(6)
  v_mfma_f32_32x32x16_bf16 v[10:25], v[88:91], v[48:51], 0
  v_exp_f32 v31, v31
  v_exp_f32 v32, v32
  v_exp_f32 v33, v33
  v_exp_f32 v34, v34
  v_exp_f32 v35, v35
  v_exp_f32 v36, v36
  v_smfmac_f32_32x32x32_bf16 v[240:255], v[104:107], v[26:33], v44
  v_exp_f32 v37, v37
  v_exp_f32 v38, v38
  v_exp_f32 v39, v39
  v_exp_f32 v40, v40
  v_exp_f32 v41, v41
  v_exp_f32 v10, v10
  v_exp_f32 v11, v11
  v_smfmac_f32_32x32x32_bf16 v[240:255], v[108:111], v[34:41], v44
  buffer_load_dwordx4 v[84:87], v5, s[28:31], s47 offen offset:2048 sc1
  s_mov_b64 exec, s[50:51]
  buffer_load_dwordx4 v[104:107], v6, s[28:31], s48 offen offset:2048 sc1
  buffer_load_dwordx4 v[108:111], v6, s[28:31], s48 offen offset:2560 sc1
  s_mov_b64 exec, -1
  v_exp_f32 v12, v12
  v_exp_f32 v13, v13
  v_exp_f32 v14, v14
  v_mfma_f32_32x32x16_bf16 v[26:41], v[88:91], v[52:55], 0
  v_exp_f32 v15, v15
  v_exp_f32 v16, v16
  v_exp_f32 v17, v17
  v_exp_f32 v18, v18
  v_exp_f32 v19, v19
  v_exp_f32 v20, v20
  v_smfmac_f32_32x32x32_bf16 v[128:143], v[112:115], v[10:17], v44
  v_exp_f32 v21, v21
  v_exp_f32 v22, v22
  v_exp_f32 v23, v23
  v_exp_f32 v24, v24
  v_exp_f32 v25, v25
  v_exp_f32 v26, v26
  v_exp_f32 v27, v27
  v_smfmac_f32_32x32x32_bf16 v[128:143], v[116:119], v[18:25], v44
  v_exp_f32 v28, v28
  v_exp_f32 v29, v29
  v_exp_f32 v30, v30
  v_mfma_f32_32x32x16_bf16 v[10:25], v[88:91], v[56:59], 0
  v_exp_f32 v31, v31
  v_exp_f32 v32, v32
  v_exp_f32 v33, v33
  v_exp_f32 v34, v34
  v_exp_f32 v35, v35
  v_exp_f32 v36, v36
  v_smfmac_f32_32x32x32_bf16 v[144:159], v[112:115], v[26:33], v44
  v_exp_f32 v37, v37
  v_exp_f32 v38, v38
  v_exp_f32 v39, v39
  v_exp_f32 v40, v40
  v_exp_f32 v41, v41
  v_exp_f32 v10, v10
  v_exp_f32 v11, v11
  v_smfmac_f32_32x32x32_bf16 v[144:159], v[116:119], v[34:41], v44
  v_exp_f32 v12, v12
  v_exp_f32 v13, v13
  v_exp_f32 v14, v14
  v_mfma_f32_32x32x16_bf16 v[26:41], v[88:91], v[60:63], 0
  v_exp_f32 v15, v15
  v_exp_f32 v16, v16
  v_exp_f32 v17, v17
  v_exp_f32 v18, v18
  v_exp_f32 v19, v19
  v_exp_f32 v20, v20
  v_smfmac_f32_32x32x32_bf16 v[160:175], v[112:115], v[10:17], v44
  v_exp_f32 v21, v21
  v_exp_f32 v22, v22
  v_exp_f32 v23, v23
  v_exp_f32 v24, v24
  v_exp_f32 v25, v25
  v_exp_f32 v26, v26
  v_exp_f32 v27, v27
  v_smfmac_f32_32x32x32_bf16 v[160:175], v[116:119], v[18:25], v44
  v_exp_f32 v28, v28
  v_exp_f32 v29, v29
  v_exp_f32 v30, v30
  v_mfma_f32_32x32x16_bf16 v[10:25], v[88:91], v[64:67], 0
  v_exp_f32 v31, v31
  v_exp_f32 v32, v32
  v_exp_f32 v33, v33
  v_exp_f32 v34, v34
  v_exp_f32 v35, v35
  v_exp_f32 v36, v36
  v_smfmac_f32_32x32x32_bf16 v[176:191], v[112:115], v[26:33], v44
  v_exp_f32 v37, v37
  v_exp_f32 v38, v38
  v_exp_f32 v39, v39
  v_exp_f32 v40, v40
  v_exp_f32 v41, v41
  v_exp_f32 v10, v10
  v_exp_f32 v11, v11
  v_smfmac_f32_32x32x32_bf16 v[176:191], v[116:119], v[34:41], v44
  v_exp_f32 v12, v12
  v_exp_f32 v13, v13
  v_exp_f32 v14, v14
  v_mfma_f32_32x32x16_bf16 v[26:41], v[88:91], v[68:71], 0
  v_exp_f32 v15, v15
  v_exp_f32 v16, v16
  v_exp_f32 v17, v17
  v_exp_f32 v18, v18
  v_exp_f32 v19, v19
  v_exp_f32 v20, v20
  v_smfmac_f32_32x32x32_bf16 v[192:207], v[112:115], v[10:17], v44
  v_exp_f32 v21, v21
  v_exp_f32 v22, v22
  v_exp_f32 v23, v23
  v_exp_f32 v24, v24
  v_exp_f32 v25, v25
  v_exp_f32 v26, v26
  v_exp_f32 v27, v27
  v_smfmac_f32_32x32x32_bf16 v[192:207], v[116:119], v[18:25], v44
  v_exp_f32 v28, v28
  v_exp_f32 v29, v29
  v_exp_f32 v30, v30
  v_mfma_f32_32x32x16_bf16 v[10:25], v[88:91], v[72:75], 0
  v_exp_f32 v31, v31
  v_exp_f32 v32, v32
  v_exp_f32 v33, v33
  v_exp_f32 v34, v34
  v_exp_f32 v35, v35
  v_exp_f32 v36, v36
  v_smfmac_f32_32x32x32_bf16 v[208:223], v[112:115], v[26:33], v44
  v_exp_f32 v37, v37
  v_exp_f32 v38, v38
  v_exp_f32 v39, v39
  v_exp_f32 v40, v40
  v_exp_f32 v41, v41
  v_exp_f32 v10, v10
  v_exp_f32 v11, v11
  v_smfmac_f32_32x32x32_bf16 v[208:223], v[116:119], v[34:41], v44
  v_exp_f32 v12, v12
  v_exp_f32 v13, v13
  v_exp_f32 v14, v14
  v_mfma_f32_32x32x16_bf16 v[26:41], v[88:91], v[76:79], 0
  v_exp_f32 v15, v15
  v_exp_f32 v16, v16
  v_exp_f32 v17, v17
  v_exp_f32 v18, v18
  v_exp_f32 v19, v19
  v_exp_f32 v20, v20
  v_smfmac_f32_32x32x32_bf16 v[224:239], v[112:115], v[10:17], v44
  v_exp_f32 v21, v21
  v_exp_f32 v22, v22
  v_exp_f32 v23, v23
  v_exp_f32 v24, v24
  v_exp_f32 v25, v25
  v_exp_f32 v26, v26
  v_exp_f32 v27, v27
  v_smfmac_f32_32x32x32_bf16 v[224:239], v[116:119], v[18:25], v44
  v_exp_f32 v28, v28
  v_exp_f32 v29, v29
  v_exp_f32 v30, v30
  s_waitcnt vmcnt(6)
  v_mfma_f32_32x32x16_bf16 v[10:25], v[92:95], v[48:51], 0
  v_exp_f32 v31, v31
  v_exp_f32 v32, v32
  v_exp_f32 v33, v33
  v_exp_f32 v34, v34
  v_exp_f32 v35, v35
  v_exp_f32 v36, v36
  v_smfmac_f32_32x32x32_bf16 v[240:255], v[112:115], v[26:33], v44
  v_exp_f32 v37, v37
  v_exp_f32 v38, v38
  v_exp_f32 v39, v39
  v_exp_f32 v40, v40
  v_exp_f32 v41, v41
  v_exp_f32 v10, v10
  v_exp_f32 v11, v11
  v_smfmac_f32_32x32x32_bf16 v[240:255], v[116:119], v[34:41], v44
  buffer_load_dwordx4 v[88:91], v5, s[28:31], s47 offen offset:3072 sc1
  s_mov_b64 exec, s[50:51]
  buffer_load_dwordx4 v[112:115], v6, s[28:31], s48 offen offset:3072 sc1
  buffer_load_dwordx4 v[116:119], v6, s[28:31], s48 offen offset:3584 sc1
  s_mov_b64 exec, -1
  v_exp_f32 v12, v12
  v_exp_f32 v13, v13
  v_exp_f32 v14, v14
  v_mfma_f32_32x32x16_bf16 v[26:41], v[92:95], v[52:55], 0
  v_exp_f32 v15, v15
  v_exp_f32 v16, v16
  v_exp_f32 v17, v17
  v_exp_f32 v18, v18
  v_exp_f32 v19, v19
  v_exp_f32 v20, v20
  v_smfmac_f32_32x32x32_bf16 v[128:143], v[120:123], v[10:17], v44
  v_exp_f32 v21, v21
  v_exp_f32 v22, v22
  v_exp_f32 v23, v23
  v_exp_f32 v24, v24
  v_exp_f32 v25, v25
  v_exp_f32 v26, v26
  v_exp_f32 v27, v27
  v_smfmac_f32_32x32x32_bf16 v[128:143], v[124:127], v[18:25], v44
  v_exp_f32 v28, v28
  v_exp_f32 v29, v29
  v_exp_f32 v30, v30
  v_mfma_f32_32x32x16_bf16 v[10:25], v[92:95], v[56:59], 0
  v_exp_f32 v31, v31
  v_exp_f32 v32, v32
  v_exp_f32 v33, v33
  v_exp_f32 v34, v34
  v_exp_f32 v35, v35
  v_exp_f32 v36, v36
  v_smfmac_f32_32x32x32_bf16 v[144:159], v[120:123], v[26:33], v44
  v_exp_f32 v37, v37
  v_exp_f32 v38, v38
  v_exp_f32 v39, v39
  v_exp_f32 v40, v40
  v_exp_f32 v41, v41
  v_exp_f32 v10, v10
  v_exp_f32 v11, v11
  v_smfmac_f32_32x32x32_bf16 v[144:159], v[124:127], v[34:41], v44
  v_exp_f32 v12, v12
  v_exp_f32 v13, v13
  v_exp_f32 v14, v14
  v_mfma_f32_32x32x16_bf16 v[26:41], v[92:95], v[60:63], 0
  v_exp_f32 v15, v15
  v_exp_f32 v16, v16
  v_exp_f32 v17, v17
  v_exp_f32 v18, v18
  v_exp_f32 v19, v19
  v_exp_f32 v20, v20
  v_smfmac_f32_32x32x32_bf16 v[160:175], v[120:123], v[10:17], v44
  s_bitcmp1_b32 s43, 0
  s_cbranch_scc1 RW_36
RWB_37:
  v_exp_f32 v21, v21
  v_exp_f32 v22, v22
  v_exp_f32 v23, v23
  v_exp_f32 v24, v24
  v_exp_f32 v25, v25
  v_exp_f32 v26, v26
  v_exp_f32 v27, v27
  v_smfmac_f32_32x32x32_bf16 v[160:175], v[124:127], v[18:25], v44
  v_exp_f32 v28, v28
  v_exp_f32 v29, v29
  v_exp_f32 v30, v30
  v_mfma_f32_32x32x16_bf16 v[10:25], v[92:95], v[64:67], 0
  v_exp_f32 v31, v31
  v_exp_f32 v32, v32
  v_exp_f32 v33, v33
  v_exp_f32 v34, v34
  v_exp_f32 v35, v35
  v_exp_f32 v36, v36
  v_smfmac_f32_32x32x32_bf16 v[176:191], v[120:123], v[26:33], v44
  s_bitcmp1_b32 s43, 1
  s_cbranch_scc1 RW_38
RWB_39:
  v_exp_f32 v37, v37
  v_exp_f32 v38, v38
  v_exp_f32 v39, v39
  v_exp_f32 v40, v40
  v_exp_f32 v41, v41
  v_exp_f32 v10, v10
  v_exp_f32 v11, v11
  v_smfmac_f32_32x32x32_bf16 v[176:191], v[124:127], v[34:41], v44
  v_exp_f32 v12, v12
  v_exp_f32 v13, v13
  v_exp_f32 v14, v14
  v_mfma_f32_32x32x16_bf16 v[26:41], v[92:95], v[68:71], 0
  v_exp_f32 v15, v15
  v_exp_f32 v16, v16
  v_exp_f32 v17, v17
  v_exp_f32 v18, v18
  v_exp_f32 v19, v19
  v_exp_f32 v20, v20
  v_smfmac_f32_32x32x32_bf16 v[192:207], v[120:123], v[10:17], v44
  s_bitcmp1_b32 s43, 2
  s_cbranch_scc1 RW_40
RWB_41:
  v_exp_f32 v21, v21
  v_exp_f32 v22, v22
  v_exp_f32 v23, v23
  v_exp_f32 v24, v24
  v_exp_f32 v25, v25
  v_exp_f32 v26, v26
  v_exp_f32 v27, v27
  v_smfmac_f32_32x32x32_bf16 v[192:207], v[124:127], v[18:25], v44
  v_exp_f32 v28, v28
  v_exp_f32 v29, v29
  v_exp_f32 v30, v30
  v_mfma_f32_32x32x16_bf16 v[10:25], v[92:95], v[72:75], 0
  v_exp_f32 v31, v31
  v_exp_f32 v32, v32
  v_exp_f32 v33, v33
  v_exp_f32 v34, v34
  v_exp_f32 v35, v35
  v_exp_f32 v36, v36
  v_smfmac_f32_32x32x32_bf16 v[208:223], v[120:123], v[26:33], v44
  s_bitcmp1_b32 s43, 3
  s_cbranch_scc1 RW_42
RWB_43:
  v_exp_f32 v37, v37
  v_exp_f32 v38, v38
  v_exp_f32 v39, v39
  v_exp_f32 v40, v40
  v_exp_f32 v41, v41
  v_exp_f32 v10, v10
  v_exp_f32 v11, v11
  v_smfmac_f32_32x32x32_bf16 v[208:223], v[124:127], v[34:41], v44
  v_exp_f32 v12, v12
  v_exp_f32 v13, v13
  v_exp_f32 v14, v14
  v_mfma_f32_32x32x16_bf16 v[26:41], v[92:95], v[76:79], 0
  v_exp_f32 v15, v15
  v_exp_f32 v16, v16
  v_exp_f32 v17, v17
  v_exp_f32 v18, v18
  v_exp_f32 v19, v19
  v_exp_f32 v20, v20
  v_smfmac_f32_32x32x32_bf16 v[224:239], v[120:123], v[10:17], v44
  s_bitcmp1_b32 s43, 4
  s_cbranch_scc1 RW_44
RWB_45:
  v_exp_f32 v21, v21
  v_exp_f32 v22, v22
  v_exp_f32 v23, v23
  v_exp_f32 v24, v24
  v_exp_f32 v25, v25
  v_exp_f32 v26, v26
  v_exp_f32 v27, v27
  v_smfmac_f32_32x32x32_bf16 v[224:239], v[124:127], v[18:25], v44
  v_exp_f32 v28, v28
  v_exp_f32 v29, v29
  v_exp_f32 v30, v30
  s_waitcnt vmcnt(6)
  v_mfma_f32_32x32x16_bf16 v[10:25], v[80:83], v[48:51], 0
  v_exp_f32 v31, v31
  v_exp_f32 v32, v32
  v_exp_f32 v33, v33
  v_exp_f32 v34, v34
  v_exp_f32 v35, v35
  v_exp_f32 v36, v36
  v_smfmac_f32_32x32x32_bf16 v[240:255], v[120:123], v[26:33], v44
  s_bitcmp1_b32 s43, 5
  s_cbranch_scc1 RW_46
RWB_47:
  v_exp_f32 v37, v37
  v_exp_f32 v38, v38
  v_exp_f32 v39, v39
  v_exp_f32 v40, v40
  v_exp_f32 v41, v41
  s_add_u32 s47, s47, 4096
  s_add_u32 s48, s48, 4096
  s_add_u32 s42, s42, 1
  s_cmp_eq_u32 s42, 3
  s_cselect_b32 s43, s45, 0
  s_cmp_lt_u32 s42, 4
  s_cbranch_scc1 K_ATT_LOOP
  s_nop 1
  v_smfmac_f32_32x32x32_bf16 v[240:255], v[124:127], v[34:41], v44
  s_mov_b32 s43, s45
  s_bitcmp1_b32 s43, 6
  s_cbranch_scc0 RWB_49
  v_add_u32 v42, s59, v5
  v_add_u32 v43, s59, v9
  ds_write_b128 v42, v[224:227] offset:0
  ds_write_b128 v42, v[228:231] offset:1024
  ds_write_b32 v43, v232 offset:2048
RWB_49:
  s_nop 7
  s_nop 1
  s_bitcmp1_b32 s43, 7
  s_cbranch_scc0 RWB_51
  v_add_u32 v42, s59, v5
  v_add_u32 v43, s59, v9
  ds_write_b128 v42, v[240:243] offset:6912
  ds_write_b128 v42, v[244:247] offset:7936
  ds_write_b32 v43, v248 offset:8960
RWB_51:
  s_branch K_ATT_RED
K_ATT_DONE:
  s_mov_b32 s43, s45
  s_bitcmp1_b32 s43, 0
  s_cbranch_scc0 RWB_53
  v_add_u32 v42, s56, v5
  v_add_u32 v43, s56, v9
  ds_write_b128 v42, v[128:131] offset:0
  ds_write_b128 v42, v[132:135] offset:1024
  ds_write_b32 v43, v136 offset:2048
RWB_53:
  s_bitcmp1_b32 s43, 1
  s_cbranch_scc0 RWB_55
  v_add_u32 v42, s56, v5
  v_add_u32 v43, s56, v9
  ds_write_b128 v42, v[144:147] offset:6912
  ds_write_b128 v42, v[148:151] offset:7936
  ds_write_b32 v43, v152 offset:8960
RWB_55:
  s_bitcmp1_b32 s43, 2
  s_cbranch_scc0 RWB_57
  v_add_u32 v42, s57, v5
  v_add_u32 v43, s57, v9
  ds_write_b128 v42, v[160:163] offset:0
  ds_write_b128 v42, v[164:167] offset:1024
  ds_write_b32 v43, v168 offset:2048
RWB_57:
  s_bitcmp1_b32 s43, 3
  s_cbranch_scc0 RWB_59
  v_add_u32 v42, s57, v5
  v_add_u32 v43, s57, v9
  ds_write_b128 v42, v[176:179] offset:6912
  ds_write_b128 v42, v[180:183] offset:7936
  ds_write_b32 v43, v184 offset:8960
RWB_59:
  s_bitcmp1_b32 s43, 4
  s_cbranch_scc0 RWB_61
  v_add_u32 v42, s58, v5
  v_add_u32 v43, s58, v9
  ds_write_b128 v42, v[192:195] offset:0
  ds_write_b128 v42, v[196:199] offset:1024
  ds_write_b32 v43, v200 offset:2048
RWB_61:
  s_bitcmp1_b32 s43, 5
  s_cbranch_scc0 RWB_63
  v_add_u32 v42, s58, v5
  v_add_u32 v43, s58, v9
  ds_write_b128 v42, v[208:211] offset:6912
  ds_write_b128 v42, v[212:215] offset:7936
  ds_write_b32 v43, v216 offset:8960
RWB_63:
  s_bitcmp1_b32 s43, 6
  s_cbranch_scc0 RWB_65
  v_add_u32 v42, s59, v5
  v_add_u32 v43, s59, v9
  ds_write_b128 v42, v[224:227] offset:0
  ds_write_b128 v42, v[228:231] offset:1024
  ds_write_b32 v43, v232 offset:2048
RWB_65:
  s_bitcmp1_b32 s43, 7
  s_cbranch_scc0 RWB_67
  v_add_u32 v42, s59, v5
  v_add_u32 v43, s59, v9
  ds_write_b128 v42, v[240:243] offset:6912
  ds_write_b128 v42, v[244:247] offset:7936
  ds_write_b32 v43, v248 offset:8960
RWB_67:
K_ATT_RED:
  s_setprio 3
  s_and_b32 s52, s2, 7
  s_lshr_b32 s53, s2, 3
  s_and_b32 s54, s53, 3
  s_lshl_b32 s52, s52, 2
  s_add_u32 s58, s52, s54
  s_lshr_b32 s59, s53, 2
  v_mov_b32 v78, 159772
  v_mov_b32 v79, 1
  s_mul_i32 s53, s36, 13824
  v_add_u32 v2, s53, v5
  v_add_u32 v7, s53, v9
  s_waitcnt lgkmcnt(0)
  s_mov_b64 exec, 1
  ds_add_u32 v78, v79
  s_mov_b64 exec, -1
  s_lshl_b32 s53, s39, 3
  s_lshl_b32 s52, s36, 1
  s_add_u32 s53, s53, s52
  s_lshl_b32 s53, s53, 5
  s_add_u32 s53, s53, s38
  s_lshl_b32 s53, s53, 10
  s_add_u32 s53, s53, 7340032
GB_68:
  ds_read_b32 v77, v78
  s_waitcnt lgkmcnt(0)
  v_readfirstlane_b32 s3, v77
  s_nop 0
  s_cmp_ge_u32 s3, 4
  s_cbranch_scc0 GB_68
  ds_read_b128 v[10:13], v2 offset:0
  ds_read_b128 v[14:17], v2 offset:1024
  ds_read_b32 v18, v7 offset:2048
  ds_read_b128 v[22:25], v2 offset:2304
  ds_read_b128 v[26:29], v2 offset:3328
  ds_read_b32 v30, v7 offset:4352
  ds_read_b128 v[32:35], v2 offset:4608
  ds_read_b128 v[36:39], v2 offset:5632
  ds_read_b32 v40, v7 offset:6656
  ds_read_b128 v[44:47], v2 offset:6912
  ds_read_b128 v[48:51], v2 offset:7936
  ds_read_b32 v52, v7 offset:8960
  ds_read_b128 v[56:59], v2 offset:9216
  ds_read_b128 v[60:63], v2 offset:10240
  ds_read_b32 v64, v7 offset:11264
  ds_read_b128 v[68:71], v2 offset:11520
  ds_read_b128 v[72:75], v2 offset:12544
  ds_read_b32 v76, v7 offset:13568
  s_waitcnt lgkmcnt(9)
  s_cmp_lg_u32 s36, 0
  s_cbranch_scc1 RFQ_70
  v_add_f32 v10, v128, v10
  v_add_f32 v11, v129, v11
  v_add_f32 v12, v130, v12
  v_add_f32 v13, v131, v13
  v_add_f32 v14, v132, v14
  v_add_f32 v15, v133, v15
  v_add_f32 v16, v134, v16
  v_add_f32 v17, v135, v17
  v_add_f32 v18, v136, v18
  s_branch RFE_69
RFQ_70:
  s_cmp_lg_u32 s36, 1
  s_cbranch_scc1 RFQ_71
  v_add_f32 v10, v160, v10
  v_add_f32 v11, v161, v11
  v_add_f32 v12, v162, v12
  v_add_f32 v13, v163, v13
  v_add_f32 v14, v164, v14
  v_add_f32 v15, v165, v15
  v_add_f32 v16, v166, v16
  v_add_f32 v17, v167, v17
  v_add_f32 v18, v168, v18
  s_branch RFE_69
RFQ_71:
  s_cmp_lg_u32 s36, 2
  s_cbranch_scc1 RFQ_72
  v_add_f32 v10, v192, v10
  v_add_f32 v11, v193, v11
  v_add_f32 v12, v194, v12
  v_add_f32 v13, v195, v13
  v_add_f32 v14, v196, v14
  v_add_f32 v15, v197, v15
  v_add_f32 v16, v198, v16
  v_add_f32 v17, v199, v17
  v_add_f32 v18, v200, v18
  s_branch RFE_69
RFQ_72:
  v_add_f32 v10, v224, v10
  v_add_f32 v11, v225, v11
  v_add_f32 v12, v226, v12
  v_add_f32 v13, v227, v13
  v_add_f32 v14, v228, v14
  v_add_f32 v15, v229, v15
  v_add_f32 v16, v230, v16
  v_add_f32 v17, v231, v17
  v_add_f32 v18, v232, v18
RFE_69:
  v_add_f32 v10, v10, v22
  v_add_f32 v11, v11, v23
  v_add_f32 v12, v12, v24
  v_add_f32 v13, v13, v25
  v_add_f32 v14, v14, v26
  v_add_f32 v15, v15, v27
  v_add_f32 v16, v16, v28
  v_add_f32 v17, v17, v29
  v_add_f32 v18, v18, v30
  v_add_f32 v10, v10, v32
  v_add_f32 v11, v11, v33
  v_add_f32 v12, v12, v34
  v_add_f32 v13, v13, v35
  v_add_f32 v14, v14, v36
  v_add_f32 v15, v15, v37
  v_add_f32 v16, v16, v38
  v_add_f32 v17, v17, v39
  v_add_f32 v18, v18, v40
  v_rcp_f32 v19, v18
  s_nop 0
  v_mul_f32 v10, v10, v19
  v_mul_f32 v11, v11, v19
  v_mul_f32 v12, v12, v19
  v_mul_f32 v13, v13, v19
  v_mul_f32 v14, v14, v19
  v_mul_f32 v15, v15, v19
  v_mul_f32 v16, v16, v19
  v_mul_f32 v17, v17, v19
  v_cvt_pk_bf16_f32 v22, v10, v11
  v_cvt_pk_bf16_f32 v23, v12, v13
  v_cvt_pk_bf16_f32 v24, v14, v15
  v_cvt_pk_bf16_f32 v25, v16, v17
  buffer_store_dwordx4 v[22:25], v5, s[28:31], s53 offen sc1
  s_add_u32 s53, s53, 32768
  s_waitcnt lgkmcnt(0)
  s_mov_b64 exec, 1
  ds_add_u32 v78, v79
  s_mov_b64 exec, -1
  s_cmp_lg_u32 s36, 0
  s_cbranch_scc1 RFQ_75
  v_add_f32 v44, v144, v44
  v_add_f32 v45, v145, v45
  v_add_f32 v46, v146, v46
  v_add_f32 v47, v147, v47
  v_add_f32 v48, v148, v48
  v_add_f32 v49, v149, v49
  v_add_f32 v50, v150, v50
  v_add_f32 v51, v151, v51
  v_add_f32 v52, v152, v52
  s_branch RFE_74
RFQ_75:
  s_cmp_lg_u32 s36, 1
  s_cbranch_scc1 RFQ_76
  v_add_f32 v44, v176, v44
  v_add_f32 v45, v177, v45
  v_add_f32 v46, v178, v46
  v_add_f32 v47, v179, v47
  v_add_f32 v48, v180, v48
  v_add_f32 v49, v181, v49
  v_add_f32 v50, v182, v50
  v_add_f32 v51, v183, v51
  v_add_f32 v52, v184, v52
  s_branch RFE_74
RFQ_76:
  s_cmp_lg_u32 s36, 2
  s_cbranch_scc1 RFQ_77
  v_add_f32 v44, v208, v44
  v_add_f32 v45, v209, v45
  v_add_f32 v46, v210, v46
  v_add_f32 v47, v211, v47
  v_add_f32 v48, v212, v48
  v_add_f32 v49, v213, v49
  v_add_f32 v50, v214, v50
  v_add_f32 v51, v215, v51
  v_add_f32 v52, v216, v52
  s_branch RFE_74
RFQ_77:
  v_add_f32 v44, v240, v44
  v_add_f32 v45, v241, v45
  v_add_f32 v46, v242, v46
  v_add_f32 v47, v243, v47
  v_add_f32 v48, v244, v48
  v_add_f32 v49, v245, v49
  v_add_f32 v50, v246, v50
  v_add_f32 v51, v247, v51
  v_add_f32 v52, v248, v52
RFE_74:
  v_add_f32 v44, v44, v56
  v_add_f32 v45, v45, v57
  v_add_f32 v46, v46, v58
  v_add_f32 v47, v47, v59
  v_add_f32 v48, v48, v60
  v_add_f32 v49, v49, v61
  v_add_f32 v50, v50, v62
  v_add_f32 v51, v51, v63
  v_add_f32 v52, v52, v64
  v_add_f32 v44, v44, v68
  v_add_f32 v45, v45, v69
  v_add_f32 v46, v46, v70
  v_add_f32 v47, v47, v71
  v_add_f32 v48, v48, v72
  v_add_f32 v49, v49, v73
  v_add_f32 v50, v50, v74
  v_add_f32 v51, v51, v75
  v_add_f32 v52, v52, v76
  v_rcp_f32 v53, v52
  s_nop 0
  v_mul_f32 v44, v44, v53
  v_mul_f32 v45, v45, v53
  v_mul_f32 v46, v46, v53
  v_mul_f32 v47, v47, v53
  v_mul_f32 v48, v48, v53
  v_mul_f32 v49, v49, v53
  v_mul_f32 v50, v50, v53
  v_mul_f32 v51, v51, v53
  v_cvt_pk_bf16_f32 v56, v44, v45
  v_cvt_pk_bf16_f32 v57, v46, v47
  v_cvt_pk_bf16_f32 v58, v48, v49
  v_cvt_pk_bf16_f32 v59, v50, v51
  buffer_store_dwordx4 v[56:59], v5, s[28:31], s53 offen sc1
  v_mov_b32 v192, 0
  v_mov_b32 v193, 0
  v_mov_b32 v194, 0
  v_mov_b32 v195, 0
  v_mov_b32 v196, 0
  v_mov_b32 v197, 0
  v_mov_b32 v198, 0
  v_mov_b32 v199, 0
  v_mov_b32 v200, 0
  v_mov_b32 v201, 0
  v_mov_b32 v202, 0
  v_mov_b32 v203, 0
  v_mov_b32 v204, 0
  v_mov_b32 v205, 0
  v_mov_b32 v206, 0
  v_mov_b32 v207, 0
  s_lshl_b32 s52, s39, 5
  s_add_u32 s52, s52, s38
  s_lshl_b32 s52, s52, 7
  s_add_u32 s52, s52, 98304
  s_waitcnt vmcnt(0)
  v_mov_b32 v46, 159752
  v_mov_b32 v47, 1
  s_mov_b64 exec, 1
  ds_add_rtn_u32 v48, v46, v47
  s_waitcnt lgkmcnt(0)
  v_readfirstlane_b32 s66, v48
  v_mov_b32 v46, s64
  v_mov_b32 v47, s65
  v_mov_b32 v48, 0
  s_cmp_eq_u32 s66, 3
  s_cbranch_scc0 SIG_79
  buffer_store_dwordx2 v[46:47], v48, s[28:31], s52 offen sc1
SIG_79:
  s_mov_b64 exec, -1
  s_setprio 0
  s_and_b32 s37, s36, 1
  s_bfe_u32 s38, s36, 0x10001
  s_lshr_b32 s39, s36, 2
  s_mov_b32 s32, s20
  s_mov_b32 s33, s21
  s_mov_b32 s34, 2097152
  s_mov_b32 s35, 0x00020000
  s_lshl_b32 s3, s58, 6
  s_lshl_b32 s42, s37, 5
  s_add_u32 s3, s3, s42
  v_add_u32 v20, s3, v3
  v_lshlrev_b32 v20, 10, v20
  s_lshl_b32 s3, s59, 6
  s_lshl_b32 s42, s38, 5
  s_add_u32 s3, s3, s42
  s_lshl_b32 s42, s39, 4
  s_add_u32 s3, s3, s42
  v_lshlrev_b32 v21, 3, v4
  v_add_u32 v21, s3, v21
  v_lshlrev_b32 v21, 1, v21
  v_add_u32 v20, v20, v21
  s_mov_b32 s44, s4
  s_mov_b32 s45, s5
  s_mov_b32 s46, 2097152
  s_mov_b32 s47, 0x00020000
  buffer_load_dwordx4 v[24:27], v20, s[44:47], 0 offen
  s_mov_b32 s44, s18
  s_mov_b32 s45, s19
  s_mov_b32 s46, 1024
  s_mov_b32 s47, 0x00020000
  buffer_load_dwordx4 v[28:31], v21, s[44:47], 0 offen
  s_lshl_b32 s3, s39, 15
  s_add_u32 s3, s3, 0
  v_bfe_u32 v13, v1, 2, 2
  v_lshlrev_b32 v14, 2, v4
  v_add_u32 v14, v14, v13
  v_lshlrev_b32 v14, 7, v14
  v_bfe_u32 v15, v1, 4, 1
  v_lshlrev_b32 v15, 1, v15
  v_and_b32 v16, 1, v1
  v_add_u32 v15, v15, v16
  v_lshrrev_b32 v13, 1, v13
  v_lshlrev_b32 v13, 2, v13
  v_xor_b32 v15, v15, v13
  v_lshlrev_b32 v15, 4, v15
  v_bfe_u32 v16, v1, 1, 1
  v_lshlrev_b32 v16, 3, v16
  v_add3_u32 v14, v14, v15, v16
  v_add_u32 v21, s3, v14
  v_xor_b32 v22, 64, v21
  s_lshl_b32 s3, s38, 6
  v_xor_b32 v21, s3, v21
  s_lshl_b32 s3, s37, 15
  s_lshl_b32 s42, s39, 14
  s_add_u32 s3, s3, s42
  s_add_u32 s3, s3, 65536
  v_add_u32 v22, s3, v5
  s_lshl_b32 s3, s38, 4
  s_lshl_b32 s42, s39, 1
  s_add_u32 s3, s3, s42
  s_lshl_b32 s40, s58, 1
  s_add_u32 s40, s40, s37
  s_lshl_b32 s40, s40, 5
  s_add_u32 s40, s40, s3
  s_lshl_b32 s40, s40, 10
  s_add_u32 s40, s40, 7340032
  s_lshl_b32 s41, s37, 5
  s_add_u32 s41, s41, s3
  s_lshl_b32 s41, s41, 10
  s_add_u32 s41, s41, 65536
  s_and_b32 s3, s36, 3
  s_lshl_b32 s3, s3, 12
  s_add_u32 s3, s3, 131072
  s_lshl_b32 s42, s39, 11
  s_add_u32 s43, s3, s42
  v_add_u32 v23, s43, v5
  s_xor_b32 s42, s42, 2048
  s_add_u32 s43, s3, s42
  v_add_u32 v6, s43, v5
  s_lshr_b32 s42, s58, 2
  s_lshl_b32 s42, s42, 12
  s_add_u32 s42, s42, 98304
  s_waitcnt vmcnt(0)
  v_lshlrev_b32 v40, 16, v24
  v_and_b32 v41, 0xffff0000, v24
  v_lshlrev_b32 v42, 16, v25
  v_and_b32 v43, 0xffff0000, v25
  v_lshlrev_b32 v44, 16, v26
  v_and_b32 v45, 0xffff0000, v26
  v_lshlrev_b32 v46, 16, v27
  v_and_b32 v47, 0xffff0000, v27
  v_lshlrev_b32 v24, 16, v28
  v_and_b32 v25, 0xffff0000, v28
  v_add_f32 v40, v40, v24
  v_add_f32 v41, v41, v25
  v_lshlrev_b32 v24, 16, v29
  v_and_b32 v25, 0xffff0000, v29
  v_add_f32 v42, v42, v24
  v_add_f32 v43, v43, v25
  v_lshlrev_b32 v24, 16, v30
  v_and_b32 v25, 0xffff0000, v30
  v_add_f32 v44, v44, v24
  v_add_f32 v45, v45, v25
  v_lshlrev_b32 v24, 16, v31
  v_and_b32 v25, 0xffff0000, v31
  v_add_f32 v46, v46, v24
  v_add_f32 v47, v47, v25
  s_cmp_eq_u32 s36, 0
  s_cbranch_scc1 K_TAIL
  v_mov_b32 v12, 159772
GB_80:
  ds_read_b32 v13, v12
  s_waitcnt lgkmcnt(0)
  v_readfirstlane_b32 s3, v13
  s_nop 0
  s_cmp_ge_u32 s3, 8
  s_cbranch_scc0 GB_80
  s_mov_b32 s24, s8
  s_mov_b32 s25, s9
  s_mov_b32 s26, 524288
  s_mov_b32 s27, 0x00020000
  v_lshrrev_b32 v10, 3, v1
  v_lshlrev_b32 v10, 10, v10
  v_and_b32 v11, 7, v1
  v_bfe_u32 v12, v1, 4, 1
  v_lshlrev_b32 v12, 2, v12
  v_xor_b32 v11, v11, v12
  v_lshlrev_b32 v11, 4, v11
  v_add_u32 v10, v10, v11
  v_add_u32 v11, 7168, v10
  s_sub_u32 s54, s36, 1
  s_lshl_b32 s52, s54, 14
  s_lshl_b32 s53, s59, 7
  s_add_u32 s52, s52, s53
  s_lshl_b32 s53, s54, 11
  s_add_u32 m0, s53, 0
  s_nop 0
  buffer_load_dwordx4 v10, s[24:27], s52 offen lds
  buffer_load_dwordx4 v11, s[24:27], s52 offen offset:1024 lds
  s_add_u32 s52, s52, 49152
  s_add_u32 m0, s53, 6144
  s_nop 0
  buffer_load_dwordx4 v10, s[24:27], s52 offen lds
  buffer_load_dwordx4 v11, s[24:27], s52 offen offset:1024 lds
  s_add_u32 s52, s52, 49152
  s_add_u32 m0, s53, 12288
  s_nop 0
  buffer_load_dwordx4 v10, s[24:27], s52 offen lds
  buffer_load_dwordx4 v11, s[24:27], s52 offen offset:1024 lds
  s_add_u32 s52, s52, 49152
  s_add_u32 m0, s53, 18432
  s_nop 0
  buffer_load_dwordx4 v10, s[24:27], s52 offen lds
  buffer_load_dwordx4 v11, s[24:27], s52 offen offset:1024 lds
  s_add_u32 s52, s52, 49152
  s_add_u32 m0, s53, 24576
  s_nop 0
  buffer_load_dwordx4 v10, s[24:27], s52 offen lds
  buffer_load_dwordx4 v11, s[24:27], s52 offen offset:1024 lds
  s_add_u32 s52, s52, 49152
  s_add_u32 m0, s53, 30720
  s_nop 0
  buffer_load_dwordx4 v10, s[24:27], s52 offen lds
  buffer_load_dwordx4 v11, s[24:27], s52 offen offset:1024 lds
  s_add_u32 s52, s52, 49152
  s_add_u32 m0, s53, 36864
  s_nop 0
  buffer_load_dwordx4 v10, s[24:27], s52 offen lds
  buffer_load_dwordx4 v11, s[24:27], s52 offen offset:1024 lds
  s_add_u32 s52, s52, 49152
  s_add_u32 m0, s53, 43008
  s_nop 0
  buffer_load_dwordx4 v10, s[24:27], s52 offen lds
  buffer_load_dwordx4 v11, s[24:27], s52 offen offset:1024 lds
  s_add_u32 s52, s52, 49152
  s_add_u32 m0, s53, 49152
  s_nop 0
  buffer_load_dwordx4 v10, s[24:27], s52 offen lds
  buffer_load_dwordx4 v11, s[24:27], s52 offen offset:1024 lds
  s_add_u32 s52, s52, 49152
  s_add_u32 m0, s53, 55296
  s_nop 0
  buffer_load_dwordx4 v10, s[24:27], s52 offen lds
  buffer_load_dwordx4 v11, s[24:27], s52 offen offset:1024 lds
  s_add_u32 s52, s52, 49152
  s_add_u32 m0, s53, 61440
  s_nop 0
  buffer_load_dwordx4 v10, s[24:27], s52 offen lds
  buffer_load_dwordx4 v11, s[24:27], s52 offen offset:1024 lds
  s_add_u32 s52, s52, 49152
K_TAIL:
  s_setprio 0
  v_lshlrev_b32 v8, 7, v1
  s_cmp_eq_u32 s36, 0
  s_cbranch_scc0 K_S3W
  s_mov_b32 s66, 0xffffffff
  s_mov_b32 s67, 0
  s_mov_b32 s68, 1048576
  s_waitcnt vmcnt(0)
  s_mov_b64 exec, s[66:67]
POLL_81:
  buffer_load_dwordx2 v[48:49], v8, s[28:31], s42 offen sc1
  s_waitcnt vmcnt(0)
  v_cmp_eq_u64 vcc, s[64:65], v[48:49]
  s_sub_u32 s68, s68, 1
  s_cmp_eq_u32 s68, 0
  s_cbranch_scc1 POLLD_82
  s_cmp_eq_u64 vcc, s[66:67]
  s_cbranch_scc1 POLLD_82
  s_sleep 2
  s_branch POLL_81
POLLD_82:
  s_mov_b64 exec, -1
K_S3W:
  s_waitcnt vmcnt(0)
  s_barrier
  s_add_u32 m0, s41, 0
  s_add_u32 s55, s40, 0
  buffer_load_dwordx4 v5, s[28:31], s55 offen sc1 lds
  buffer_load_dwordx4 v5, s[28:31], s55 offen offset:1024 sc1 lds
  s_add_u32 m0, s41, 4096
  s_add_u32 s55, s40, 4096
  buffer_load_dwordx4 v5, s[28:31], s55 offen sc1 lds
  buffer_load_dwordx4 v5, s[28:31], s55 offen offset:1024 sc1 lds
  s_add_u32 m0, s41, 8192
  s_add_u32 s55, s40, 8192
  buffer_load_dwordx4 v5, s[28:31], s55 offen sc1 lds
  buffer_load_dwordx4 v5, s[28:31], s55 offen offset:1024 sc1 lds
  s_add_u32 m0, s41, 12288
  s_add_u32 s55, s40, 12288
  buffer_load_dwordx4 v5, s[28:31], s55 offen sc1 lds
  buffer_load_dwordx4 v5, s[28:31], s55 offen offset:1024 sc1 lds
  s_cmp_eq_u32 s2, 0
  s_cbranch_scc0 K_NOE
  s_cmp_eq_u32 s36, 0
  s_cbranch_scc0 K_NOE
  v_mov_b32 v60, s64
  v_mov_b32 v61, s65
  v_mov_b32 v62, 0
  s_mov_b64 exec, 1
  buffer_store_dwordx2 v[60:61], v62, s[28:31], 0 offen
  s_mov_b64 exec, -1
  s_waitcnt vmcnt(0)
K_NOE:
  s_waitcnt vmcnt(6)
  s_barrier
  ds_read_b128 v[64:67], v22 offset:0
  ds_read_b64_tr_b16 v[80:81], v21 offset:0
  ds_read_b64_tr_b16 v[82:83], v21 offset:1024
  ds_read_b128 v[68:71], v22 offset:1024
  ds_read_b64_tr_b16 v[84:85], v21 offset:2048
  ds_read_b64_tr_b16 v[86:87], v21 offset:3072
  ds_read_b128 v[72:75], v22 offset:2048
  ds_read_b64_tr_b16 v[88:89], v21 offset:4096
  ds_read_b64_tr_b16 v[90:91], v21 offset:5120
  ds_read_b128 v[76:79], v22 offset:3072
  ds_read_b64_tr_b16 v[92:93], v21 offset:6144
  ds_read_b64_tr_b16 v[94:95], v21 offset:7168
  s_waitcnt lgkmcnt(9)
  v_mfma_f32_32x32x16_bf16 v[192:207], v[80:83], v[64:67], v[192:207]
  s_waitcnt lgkmcnt(6)
  v_mfma_f32_32x32x16_bf16 v[192:207], v[84:87], v[68:71], v[192:207]
  s_waitcnt lgkmcnt(3)
  v_mfma_f32_32x32x16_bf16 v[192:207], v[88:91], v[72:75], v[192:207]
  s_waitcnt lgkmcnt(0)
  v_mfma_f32_32x32x16_bf16 v[192:207], v[92:95], v[76:79], v[192:207]
  s_waitcnt vmcnt(4)
  s_barrier
  ds_read_b128 v[64:67], v22 offset:4096
  ds_read_b64_tr_b16 v[80:81], v21 offset:8192
  ds_read_b64_tr_b16 v[82:83], v21 offset:9216
  ds_read_b128 v[68:71], v22 offset:5120
  ds_read_b64_tr_b16 v[84:85], v21 offset:10240
  ds_read_b64_tr_b16 v[86:87], v21 offset:11264
  ds_read_b128 v[72:75], v22 offset:6144
  ds_read_b64_tr_b16 v[88:89], v21 offset:12288
  ds_read_b64_tr_b16 v[90:91], v21 offset:13312
  ds_read_b128 v[76:79], v22 offset:7168
  ds_read_b64_tr_b16 v[92:93], v21 offset:14336
  ds_read_b64_tr_b16 v[94:95], v21 offset:15360
  s_waitcnt lgkmcnt(9)
  v_mfma_f32_32x32x16_bf16 v[192:207], v[80:83], v[64:67], v[192:207]
  s_waitcnt lgkmcnt(6)
  v_mfma_f32_32x32x16_bf16 v[192:207], v[84:87], v[68:71], v[192:207]
  s_waitcnt lgkmcnt(3)
  v_mfma_f32_32x32x16_bf16 v[192:207], v[88:91], v[72:75], v[192:207]
  s_waitcnt lgkmcnt(0)
  v_mfma_f32_32x32x16_bf16 v[192:207], v[92:95], v[76:79], v[192:207]
  s_waitcnt vmcnt(2)
  s_barrier
  ds_read_b128 v[64:67], v22 offset:8192
  ds_read_b64_tr_b16 v[80:81], v21 offset:16384
  ds_read_b64_tr_b16 v[82:83], v21 offset:17408
  ds_read_b128 v[68:71], v22 offset:9216
  ds_read_b64_tr_b16 v[84:85], v21 offset:18432
  ds_read_b64_tr_b16 v[86:87], v21 offset:19456
  ds_read_b128 v[72:75], v22 offset:10240
  ds_read_b64_tr_b16 v[88:89], v21 offset:20480
  ds_read_b64_tr_b16 v[90:91], v21 offset:21504
  ds_read_b128 v[76:79], v22 offset:11264
  ds_read_b64_tr_b16 v[92:93], v21 offset:22528
  ds_read_b64_tr_b16 v[94:95], v21 offset:23552
  s_waitcnt lgkmcnt(9)
  v_mfma_f32_32x32x16_bf16 v[192:207], v[80:83], v[64:67], v[192:207]
  s_waitcnt lgkmcnt(6)
  v_mfma_f32_32x32x16_bf16 v[192:207], v[84:87], v[68:71], v[192:207]
  s_waitcnt lgkmcnt(3)
  v_mfma_f32_32x32x16_bf16 v[192:207], v[88:91], v[72:75], v[192:207]
  s_waitcnt lgkmcnt(0)
  v_mfma_f32_32x32x16_bf16 v[192:207], v[92:95], v[76:79], v[192:207]
  s_waitcnt vmcnt(0)
  s_barrier
  ds_read_b128 v[64:67], v22 offset:12288
  ds_read_b64_tr_b16 v[80:81], v21 offset:24576
  ds_read_b64_tr_b16 v[82:83], v21 offset:25600
  ds_read_b128 v[68:71], v22 offset:13312
  ds_read_b64_tr_b16 v[84:85], v21 offset:26624
  ds_read_b64_tr_b16 v[86:87], v21 offset:27648
  ds_read_b128 v[72:75], v22 offset:14336
  ds_read_b64_tr_b16 v[88:89], v21 offset:28672
  ds_read_b64_tr_b16 v[90:91], v21 offset:29696
  ds_read_b128 v[76:79], v22 offset:15360
  ds_read_b64_tr_b16 v[92:93], v21 offset:30720
  ds_read_b64_tr_b16 v[94:95], v21 offset:31744
  s_waitcnt lgkmcnt(9)
  v_mfma_f32_32x32x16_bf16 v[192:207], v[80:83], v[64:67], v[192:207]
  s_waitcnt lgkmcnt(6)
  v_mfma_f32_32x32x16_bf16 v[192:207], v[84:87], v[68:71], v[192:207]
  s_waitcnt lgkmcnt(3)
  v_mfma_f32_32x32x16_bf16 v[192:207], v[88:91], v[72:75], v[192:207]
  s_waitcnt lgkmcnt(0)
  v_mfma_f32_32x32x16_bf16 v[192:207], v[92:95], v[76:79], v[192:207]
  s_cmp_eq_u32 s39, 0
  s_cbranch_scc1 K_KH0
  s_nop 7
  s_nop 3
  ds_write_b128 v23, v[192:195]
  ds_write_b128 v23, v[196:199] offset:1024
  v_add_f32 v40, v40, v200
  v_add_f32 v41, v41, v201
  v_add_f32 v42, v42, v202
  v_add_f32 v43, v43, v203
  v_add_f32 v44, v44, v204
  v_add_f32 v45, v45, v205
  v_add_f32 v46, v46, v206
  v_add_f32 v47, v47, v207
  s_branch K_EX
K_KH0:
  s_nop 7
  s_nop 3
  ds_write_b128 v23, v[200:203]
  ds_write_b128 v23, v[204:207] offset:1024
  v_add_f32 v40, v40, v192
  v_add_f32 v41, v41, v193
  v_add_f32 v42, v42, v194
  v_add_f32 v43, v43, v195
  v_add_f32 v44, v44, v196
  v_add_f32 v45, v45, v197
  v_add_f32 v46, v46, v198
  v_add_f32 v47, v47, v199
K_EX:
  s_waitcnt lgkmcnt(0)
  s_barrier
  ds_read_b128 v[64:67], v6
  ds_read_b128 v[68:71], v6 offset:1024
  s_waitcnt lgkmcnt(0)
  v_add_f32 v40, v40, v64
  v_add_f32 v41, v41, v65
  v_add_f32 v42, v42, v66
  v_add_f32 v43, v43, v67
  v_add_f32 v44, v44, v68
  v_add_f32 v45, v45, v69
  v_add_f32 v46, v46, v70
  v_add_f32 v47, v47, v71
  v_cvt_pk_bf16_f32 v64, v40, v41
  v_cvt_pk_bf16_f32 v65, v42, v43
  v_cvt_pk_bf16_f32 v66, v44, v45
  v_cvt_pk_bf16_f32 v67, v46, v47
  buffer_store_dwordx4 v[64:67], v20, s[32:35], 0 offen
  s_endpgm
K_SLOW:
  s_waitcnt vmcnt(0)
  s_nop 7
  s_nop 7
  v_mov_b32 v128, 0
  v_mov_b32 v129, 0
  v_mov_b32 v130, 0
  v_mov_b32 v131, 0
  v_mov_b32 v132, 0
  v_mov_b32 v133, 0
  v_mov_b32 v134, 0
  v_mov_b32 v135, 0
  v_mov_b32 v136, 0
  v_mov_b32 v137, 0
  v_mov_b32 v138, 0
  v_mov_b32 v139, 0
  v_mov_b32 v140, 0
  v_mov_b32 v141, 0
  v_mov_b32 v142, 0
  v_mov_b32 v143, 0
  v_mov_b32 v144, 0
  v_mov_b32 v145, 0
  v_mov_b32 v146, 0
  v_mov_b32 v147, 0
  v_mov_b32 v148, 0
  v_mov_b32 v149, 0
  v_mov_b32 v150, 0
  v_mov_b32 v151, 0
  v_mov_b32 v152, 0
  v_mov_b32 v153, 0
  v_mov_b32 v154, 0
  v_mov_b32 v155, 0
  v_mov_b32 v156, 0
  v_mov_b32 v157, 0
  v_mov_b32 v158, 0
  v_mov_b32 v159, 0
  v_mov_b32 v160, 0
  v_mov_b32 v161, 0
  v_mov_b32 v162, 0
  v_mov_b32 v163, 0
  v_mov_b32 v164, 0
  v_mov_b32 v165, 0
  v_mov_b32 v166, 0
  v_mov_b32 v167, 0
  v_mov_b32 v168, 0
  v_mov_b32 v169, 0
  v_mov_b32 v170, 0
  v_mov_b32 v171, 0
  v_mov_b32 v172, 0
  v_mov_b32 v173, 0
  v_mov_b32 v174, 0
  v_mov_b32 v175, 0
  v_mov_b32 v176, 0
  v_mov_b32 v177, 0
  v_mov_b32 v178, 0
  v_mov_b32 v179, 0
  v_mov_b32 v180, 0
  v_mov_b32 v181, 0
  v_mov_b32 v182, 0
  v_mov_b32 v183, 0
  v_mov_b32 v184, 0
  v_mov_b32 v185, 0
  v_mov_b32 v186, 0
  v_mov_b32 v187, 0
  v_mov_b32 v188, 0
  v_mov_b32 v189, 0
  v_mov_b32 v190, 0
  v_mov_b32 v191, 0
  v_mov_b32 v192, 0
  v_mov_b32 v193, 0
  v_mov_b32 v194, 0
  v_mov_b32 v195, 0
  v_mov_b32 v196, 0
  v_mov_b32 v197, 0
  v_mov_b32 v198, 0
  v_mov_b32 v199, 0
  v_mov_b32 v200, 0
  v_mov_b32 v201, 0
  v_mov_b32 v202, 0
  v_mov_b32 v203, 0
  v_mov_b32 v204, 0
  v_mov_b32 v205, 0
  v_mov_b32 v206, 0
  v_mov_b32 v207, 0
  v_mov_b32 v208, 0
  v_mov_b32 v209, 0
  v_mov_b32 v210, 0
  v_mov_b32 v211, 0
  v_mov_b32 v212, 0
  v_mov_b32 v213, 0
  v_mov_b32 v214, 0
  v_mov_b32 v215, 0
  v_mov_b32 v216, 0
  v_mov_b32 v217, 0
  v_mov_b32 v218, 0
  v_mov_b32 v219, 0
  v_mov_b32 v220, 0
  v_mov_b32 v221, 0
  v_mov_b32 v222, 0
  v_mov_b32 v223, 0
  v_mov_b32 v224, 0
  v_mov_b32 v225, 0
  v_mov_b32 v226, 0
  v_mov_b32 v227, 0
  v_mov_b32 v228, 0
  v_mov_b32 v229, 0
  v_mov_b32 v230, 0
  v_mov_b32 v231, 0
  v_mov_b32 v232, 0
  v_mov_b32 v233, 0
  v_mov_b32 v234, 0
  v_mov_b32 v235, 0
  v_mov_b32 v236, 0
  v_mov_b32 v237, 0
  v_mov_b32 v238, 0
  v_mov_b32 v239, 0
  v_mov_b32 v240, 0
  v_mov_b32 v241, 0
  v_mov_b32 v242, 0
  v_mov_b32 v243, 0
  v_mov_b32 v244, 0
  v_mov_b32 v245, 0
  v_mov_b32 v246, 0
  v_mov_b32 v247, 0
  v_mov_b32 v248, 0
  v_mov_b32 v249, 0
  v_mov_b32 v250, 0
  v_mov_b32 v251, 0
  v_mov_b32 v252, 0
  v_mov_b32 v253, 0
  v_mov_b32 v254, 0
  v_mov_b32 v255, 0
  s_mov_b32 s61, s40
  v_mov_b32 v116, 0xff800000
  v_mov_b32 v117, 0xff800000
  v_mov_b32 v118, 0xff800000
  v_mov_b32 v119, 0xff800000
  v_mov_b32 v120, 0xff800000
  v_mov_b32 v121, 0xff800000
  v_mov_b32 v122, 0xff800000
  v_mov_b32 v123, 0xff800000
  s_mov_b32 s62, 0
K_S1:
  buffer_load_dwordx4 v[80:83], v5, s[28:31], s61 offen sc1
  s_waitcnt vmcnt(0)
  v_mfma_f32_32x32x16_bf16 v[10:25], v[80:83], v[48:51], 0
  s_nop 7
  s_nop 7
  v_max3_f32 v116, v116, v10, v11
  v_max3_f32 v116, v116, v12, v13
  v_max3_f32 v116, v116, v14, v15
  v_max3_f32 v116, v116, v16, v17
  v_max3_f32 v116, v116, v18, v19
  v_max3_f32 v116, v116, v20, v21
  v_max3_f32 v116, v116, v22, v23
  v_max3_f32 v116, v116, v24, v25
  v_mfma_f32_32x32x16_bf16 v[10:25], v[80:83], v[52:55], 0
  s_nop 7
  s_nop 7
  v_max3_f32 v117, v117, v10, v11
  v_max3_f32 v117, v117, v12, v13
  v_max3_f32 v117, v117, v14, v15
  v_max3_f32 v117, v117, v16, v17
  v_max3_f32 v117, v117, v18, v19
  v_max3_f32 v117, v117, v20, v21
  v_max3_f32 v117, v117, v22, v23
  v_max3_f32 v117, v117, v24, v25
  v_mfma_f32_32x32x16_bf16 v[10:25], v[80:83], v[56:59], 0
  s_nop 7
  s_nop 7
  v_max3_f32 v118, v118, v10, v11
  v_max3_f32 v118, v118, v12, v13
  v_max3_f32 v118, v118, v14, v15
  v_max3_f32 v118, v118, v16, v17
  v_max3_f32 v118, v118, v18, v19
  v_max3_f32 v118, v118, v20, v21
  v_max3_f32 v118, v118, v22, v23
  v_max3_f32 v118, v118, v24, v25
  v_mfma_f32_32x32x16_bf16 v[10:25], v[80:83], v[60:63], 0
  s_nop 7
  s_nop 7
  v_max3_f32 v119, v119, v10, v11
  v_max3_f32 v119, v119, v12, v13
  v_max3_f32 v119, v119, v14, v15
  v_max3_f32 v119, v119, v16, v17
  v_max3_f32 v119, v119, v18, v19
  v_max3_f32 v119, v119, v20, v21
  v_max3_f32 v119, v119, v22, v23
  v_max3_f32 v119, v119, v24, v25
  v_mfma_f32_32x32x16_bf16 v[10:25], v[80:83], v[64:67], 0
  s_nop 7
  s_nop 7
  v_max3_f32 v120, v120, v10, v11
  v_max3_f32 v120, v120, v12, v13
  v_max3_f32 v120, v120, v14, v15
  v_max3_f32 v120, v120, v16, v17
  v_max3_f32 v120, v120, v18, v19
  v_max3_f32 v120, v120, v20, v21
  v_max3_f32 v120, v120, v22, v23
  v_max3_f32 v120, v120, v24, v25
  v_mfma_f32_32x32x16_bf16 v[10:25], v[80:83], v[68:71], 0
  s_nop 7
  s_nop 7
  v_max3_f32 v121, v121, v10, v11
  v_max3_f32 v121, v121, v12, v13
  v_max3_f32 v121, v121, v14, v15
  v_max3_f32 v121, v121, v16, v17
  v_max3_f32 v121, v121, v18, v19
  v_max3_f32 v121, v121, v20, v21
  v_max3_f32 v121, v121, v22, v23
  v_max3_f32 v121, v121, v24, v25
  v_mfma_f32_32x32x16_bf16 v[10:25], v[80:83], v[72:75], 0
  s_nop 7
  s_nop 7
  v_max3_f32 v122, v122, v10, v11
  v_max3_f32 v122, v122, v12, v13
  v_max3_f32 v122, v122, v14, v15
  v_max3_f32 v122, v122, v16, v17
  v_max3_f32 v122, v122, v18, v19
  v_max3_f32 v122, v122, v20, v21
  v_max3_f32 v122, v122, v22, v23
  v_max3_f32 v122, v122, v24, v25
  v_mfma_f32_32x32x16_bf16 v[10:25], v[80:83], v[76:79], 0
  s_nop 7
  s_nop 7
  v_max3_f32 v123, v123, v10, v11
  v_max3_f32 v123, v123, v12, v13
  v_max3_f32 v123, v123, v14, v15
  v_max3_f32 v123, v123, v16, v17
  v_max3_f32 v123, v123, v18, v19
  v_max3_f32 v123, v123, v20, v21
  v_max3_f32 v123, v123, v22, v23
  v_max3_f32 v123, v123, v24, v25
  s_add_u32 s61, s61, 1024
  s_add_u32 s62, s62, 1
  s_cmp_lt_u32 s62, 16
  s_cbranch_scc1 K_S1
  v_mov_b32 v10, v116
  v_mov_b32 v11, v117
  v_mov_b32 v12, v118
  v_mov_b32 v13, v119
  v_mov_b32 v14, v120
  v_mov_b32 v15, v121
  v_mov_b32 v16, v122
  v_mov_b32 v17, v123
  s_nop 1
  v_permlane32_swap_b32 v116, v10
  v_permlane32_swap_b32 v117, v11
  v_permlane32_swap_b32 v118, v12
  v_permlane32_swap_b32 v119, v13
  v_permlane32_swap_b32 v120, v14
  v_permlane32_swap_b32 v121, v15
  v_permlane32_swap_b32 v122, v16
  v_permlane32_swap_b32 v123, v17
  s_nop 1
  v_max_f32 v116, v116, v10
  v_max_f32 v117, v117, v11
  v_max_f32 v118, v118, v12
  v_max_f32 v119, v119, v13
  v_max_f32 v120, v120, v14
  v_max_f32 v121, v121, v15
  v_max_f32 v122, v122, v16
  v_max_f32 v123, v123, v17
  v_mov_b32 v12, 159756
GB_83:
  ds_read_b32 v13, v12
  s_waitcnt lgkmcnt(0)
  v_readfirstlane_b32 s3, v13
  s_nop 0
  s_cmp_ge_u32 s3, 20
  s_cbranch_scc0 GB_83
  s_lshl_b32 s53, s36, 11
  s_add_u32 s53, s53, 57344
  v_add_u32 v42, s53, v9
  ds_write_b32 v42, v116 offset:0
  ds_write_b32 v42, v117 offset:256
  ds_write_b32 v42, v118 offset:512
  ds_write_b32 v42, v119 offset:768
  ds_write_b32 v42, v120 offset:1024
  ds_write_b32 v42, v121 offset:1280
  ds_write_b32 v42, v122 offset:1536
  ds_write_b32 v42, v123 offset:1792
  v_mov_b32 v12, 159760
  v_mov_b32 v13, 1
  s_waitcnt lgkmcnt(0)
  s_mov_b64 exec, 1
  ds_add_u32 v12, v13
  s_mov_b64 exec, -1
GB_84:
  ds_read_b32 v13, v12
  s_waitcnt lgkmcnt(0)
  v_readfirstlane_b32 s3, v13
  s_nop 0
  s_cmp_ge_u32 s3, 4
  s_cbranch_scc0 GB_84
  v_add_u32 v42, 57344, v9
  ds_read_b32 v10, v42 offset:0
  ds_read_b32 v11, v42 offset:256
  ds_read_b32 v12, v42 offset:512
  ds_read_b32 v13, v42 offset:768
  ds_read_b32 v14, v42 offset:1024
  ds_read_b32 v15, v42 offset:1280
  ds_read_b32 v16, v42 offset:1536
  ds_read_b32 v17, v42 offset:1792
  s_waitcnt lgkmcnt(0)
  v_max_f32 v116, v116, v10
  v_max_f32 v117, v117, v11
  v_max_f32 v118, v118, v12
  v_max_f32 v119, v119, v13
  v_max_f32 v120, v120, v14
  v_max_f32 v121, v121, v15
  v_max_f32 v122, v122, v16
  v_max_f32 v123, v123, v17
  ds_read_b32 v10, v42 offset:2048
  ds_read_b32 v11, v42 offset:2304
  ds_read_b32 v12, v42 offset:2560
  ds_read_b32 v13, v42 offset:2816
  ds_read_b32 v14, v42 offset:3072
  ds_read_b32 v15, v42 offset:3328
  ds_read_b32 v16, v42 offset:3584
  ds_read_b32 v17, v42 offset:3840
  s_waitcnt lgkmcnt(0)
  v_max_f32 v116, v116, v10
  v_max_f32 v117, v117, v11
  v_max_f32 v118, v118, v12
  v_max_f32 v119, v119, v13
  v_max_f32 v120, v120, v14
  v_max_f32 v121, v121, v15
  v_max_f32 v122, v122, v16
  v_max_f32 v123, v123, v17
  ds_read_b32 v10, v42 offset:4096
  ds_read_b32 v11, v42 offset:4352
  ds_read_b32 v12, v42 offset:4608
  ds_read_b32 v13, v42 offset:4864
  ds_read_b32 v14, v42 offset:5120
  ds_read_b32 v15, v42 offset:5376
  ds_read_b32 v16, v42 offset:5632
  ds_read_b32 v17, v42 offset:5888
  s_waitcnt lgkmcnt(0)
  v_max_f32 v116, v116, v10
  v_max_f32 v117, v117, v11
  v_max_f32 v118, v118, v12
  v_max_f32 v119, v119, v13
  v_max_f32 v120, v120, v14
  v_max_f32 v121, v121, v15
  v_max_f32 v122, v122, v16
  v_max_f32 v123, v123, v17
  ds_read_b32 v10, v42 offset:6144
  ds_read_b32 v11, v42 offset:6400
  ds_read_b32 v12, v42 offset:6656
  ds_read_b32 v13, v42 offset:6912
  ds_read_b32 v14, v42 offset:7168
  ds_read_b32 v15, v42 offset:7424
  ds_read_b32 v16, v42 offset:7680
  ds_read_b32 v17, v42 offset:7936
  s_waitcnt lgkmcnt(0)
  v_max_f32 v116, v116, v10
  v_max_f32 v117, v117, v11
  v_max_f32 v118, v118, v12
  v_max_f32 v119, v119, v13
  v_max_f32 v120, v120, v14
  v_max_f32 v121, v121, v15
  v_max_f32 v122, v122, v16
  v_max_f32 v123, v123, v17
  s_mov_b32 s61, s40
  s_mov_b32 s60, s41
  s_mov_b32 s62, 0
K_S2:
  buffer_load_dwordx4 v[80:83], v5, s[28:31], s61 offen sc1
  s_mov_b64 exec, s[50:51]
  buffer_load_dwordx4 v[96:99], v6, s[28:31], s60 offen sc1
  buffer_load_dwordx4 v[100:103], v6, s[28:31], s60 offen offset:512 sc1
  s_mov_b64 exec, -1
  s_waitcnt vmcnt(0)
  v_mfma_f32_32x32x16_bf16 v[10:25], v[80:83], v[48:51], 0
  s_nop 7
  s_nop 7
  v_sub_f32 v10, v10, v116
  v_sub_f32 v11, v11, v116
  v_sub_f32 v12, v12, v116
  v_sub_f32 v13, v13, v116
  v_sub_f32 v14, v14, v116
  v_sub_f32 v15, v15, v116
  v_sub_f32 v16, v16, v116
  v_sub_f32 v17, v17, v116
  v_sub_f32 v18, v18, v116
  v_sub_f32 v19, v19, v116
  v_sub_f32 v20, v20, v116
  v_sub_f32 v21, v21, v116
  v_sub_f32 v22, v22, v116
  v_sub_f32 v23, v23, v116
  v_sub_f32 v24, v24, v116
  v_sub_f32 v25, v25, v116
  v_exp_f32 v10, v10
  v_exp_f32 v11, v11
  v_exp_f32 v12, v12
  v_exp_f32 v13, v13
  v_exp_f32 v14, v14
  v_exp_f32 v15, v15
  v_exp_f32 v16, v16
  v_exp_f32 v17, v17
  v_exp_f32 v18, v18
  v_exp_f32 v19, v19
  v_exp_f32 v20, v20
  v_exp_f32 v21, v21
  v_exp_f32 v22, v22
  v_exp_f32 v23, v23
  v_exp_f32 v24, v24
  v_exp_f32 v25, v25
  s_nop 1
  v_smfmac_f32_32x32x32_bf16 v[128:143], v[96:99], v[10:17], v44
  v_smfmac_f32_32x32x32_bf16 v[128:143], v[100:103], v[18:25], v44
  s_nop 7
  v_mfma_f32_32x32x16_bf16 v[10:25], v[80:83], v[52:55], 0
  s_nop 7
  s_nop 7
  v_sub_f32 v10, v10, v117
  v_sub_f32 v11, v11, v117
  v_sub_f32 v12, v12, v117
  v_sub_f32 v13, v13, v117
  v_sub_f32 v14, v14, v117
  v_sub_f32 v15, v15, v117
  v_sub_f32 v16, v16, v117
  v_sub_f32 v17, v17, v117
  v_sub_f32 v18, v18, v117
  v_sub_f32 v19, v19, v117
  v_sub_f32 v20, v20, v117
  v_sub_f32 v21, v21, v117
  v_sub_f32 v22, v22, v117
  v_sub_f32 v23, v23, v117
  v_sub_f32 v24, v24, v117
  v_sub_f32 v25, v25, v117
  v_exp_f32 v10, v10
  v_exp_f32 v11, v11
  v_exp_f32 v12, v12
  v_exp_f32 v13, v13
  v_exp_f32 v14, v14
  v_exp_f32 v15, v15
  v_exp_f32 v16, v16
  v_exp_f32 v17, v17
  v_exp_f32 v18, v18
  v_exp_f32 v19, v19
  v_exp_f32 v20, v20
  v_exp_f32 v21, v21
  v_exp_f32 v22, v22
  v_exp_f32 v23, v23
  v_exp_f32 v24, v24
  v_exp_f32 v25, v25
  s_nop 1
  v_smfmac_f32_32x32x32_bf16 v[144:159], v[96:99], v[10:17], v44
  v_smfmac_f32_32x32x32_bf16 v[144:159], v[100:103], v[18:25], v44
  s_nop 7
  v_mfma_f32_32x32x16_bf16 v[10:25], v[80:83], v[56:59], 0
  s_nop 7
  s_nop 7
  v_sub_f32 v10, v10, v118
  v_sub_f32 v11, v11, v118
  v_sub_f32 v12, v12, v118
  v_sub_f32 v13, v13, v118
  v_sub_f32 v14, v14, v118
  v_sub_f32 v15, v15, v118
  v_sub_f32 v16, v16, v118
  v_sub_f32 v17, v17, v118
  v_sub_f32 v18, v18, v118
  v_sub_f32 v19, v19, v118
  v_sub_f32 v20, v20, v118
  v_sub_f32 v21, v21, v118
  v_sub_f32 v22, v22, v118
  v_sub_f32 v23, v23, v118
  v_sub_f32 v24, v24, v118
  v_sub_f32 v25, v25, v118
  v_exp_f32 v10, v10
  v_exp_f32 v11, v11
  v_exp_f32 v12, v12
  v_exp_f32 v13, v13
  v_exp_f32 v14, v14
  v_exp_f32 v15, v15
  v_exp_f32 v16, v16
  v_exp_f32 v17, v17
  v_exp_f32 v18, v18
  v_exp_f32 v19, v19
  v_exp_f32 v20, v20
  v_exp_f32 v21, v21
  v_exp_f32 v22, v22
  v_exp_f32 v23, v23
  v_exp_f32 v24, v24
  v_exp_f32 v25, v25
  s_nop 1
  v_smfmac_f32_32x32x32_bf16 v[160:175], v[96:99], v[10:17], v44
  v_smfmac_f32_32x32x32_bf16 v[160:175], v[100:103], v[18:25], v44
  s_nop 7
  v_mfma_f32_32x32x16_bf16 v[10:25], v[80:83], v[60:63], 0
  s_nop 7
  s_nop 7
  v_sub_f32 v10, v10, v119
  v_sub_f32 v11, v11, v119
  v_sub_f32 v12, v12, v119
  v_sub_f32 v13, v13, v119
  v_sub_f32 v14, v14, v119
  v_sub_f32 v15, v15, v119
  v_sub_f32 v16, v16, v119
  v_sub_f32 v17, v17, v119
  v_sub_f32 v18, v18, v119
  v_sub_f32 v19, v19, v119
  v_sub_f32 v20, v20, v119
  v_sub_f32 v21, v21, v119
  v_sub_f32 v22, v22, v119
  v_sub_f32 v23, v23, v119
  v_sub_f32 v24, v24, v119
  v_sub_f32 v25, v25, v119
  v_exp_f32 v10, v10
  v_exp_f32 v11, v11
  v_exp_f32 v12, v12
  v_exp_f32 v13, v13
  v_exp_f32 v14, v14
  v_exp_f32 v15, v15
  v_exp_f32 v16, v16
  v_exp_f32 v17, v17
  v_exp_f32 v18, v18
  v_exp_f32 v19, v19
  v_exp_f32 v20, v20
  v_exp_f32 v21, v21
  v_exp_f32 v22, v22
  v_exp_f32 v23, v23
  v_exp_f32 v24, v24
  v_exp_f32 v25, v25
  s_nop 1
  v_smfmac_f32_32x32x32_bf16 v[176:191], v[96:99], v[10:17], v44
  v_smfmac_f32_32x32x32_bf16 v[176:191], v[100:103], v[18:25], v44
  s_nop 7
  v_mfma_f32_32x32x16_bf16 v[10:25], v[80:83], v[64:67], 0
  s_nop 7
  s_nop 7
  v_sub_f32 v10, v10, v120
  v_sub_f32 v11, v11, v120
  v_sub_f32 v12, v12, v120
  v_sub_f32 v13, v13, v120
  v_sub_f32 v14, v14, v120
  v_sub_f32 v15, v15, v120
  v_sub_f32 v16, v16, v120
  v_sub_f32 v17, v17, v120
  v_sub_f32 v18, v18, v120
  v_sub_f32 v19, v19, v120
  v_sub_f32 v20, v20, v120
  v_sub_f32 v21, v21, v120
  v_sub_f32 v22, v22, v120
  v_sub_f32 v23, v23, v120
  v_sub_f32 v24, v24, v120
  v_sub_f32 v25, v25, v120
  v_exp_f32 v10, v10
  v_exp_f32 v11, v11
  v_exp_f32 v12, v12
  v_exp_f32 v13, v13
  v_exp_f32 v14, v14
  v_exp_f32 v15, v15
  v_exp_f32 v16, v16
  v_exp_f32 v17, v17
  v_exp_f32 v18, v18
  v_exp_f32 v19, v19
  v_exp_f32 v20, v20
  v_exp_f32 v21, v21
  v_exp_f32 v22, v22
  v_exp_f32 v23, v23
  v_exp_f32 v24, v24
  v_exp_f32 v25, v25
  s_nop 1
  v_smfmac_f32_32x32x32_bf16 v[192:207], v[96:99], v[10:17], v44
  v_smfmac_f32_32x32x32_bf16 v[192:207], v[100:103], v[18:25], v44
  s_nop 7
  v_mfma_f32_32x32x16_bf16 v[10:25], v[80:83], v[68:71], 0
  s_nop 7
  s_nop 7
  v_sub_f32 v10, v10, v121
  v_sub_f32 v11, v11, v121
  v_sub_f32 v12, v12, v121
  v_sub_f32 v13, v13, v121
  v_sub_f32 v14, v14, v121
  v_sub_f32 v15, v15, v121
  v_sub_f32 v16, v16, v121
  v_sub_f32 v17, v17, v121
  v_sub_f32 v18, v18, v121
  v_sub_f32 v19, v19, v121
  v_sub_f32 v20, v20, v121
  v_sub_f32 v21, v21, v121
  v_sub_f32 v22, v22, v121
  v_sub_f32 v23, v23, v121
  v_sub_f32 v24, v24, v121
  v_sub_f32 v25, v25, v121
  v_exp_f32 v10, v10
  v_exp_f32 v11, v11
  v_exp_f32 v12, v12
  v_exp_f32 v13, v13
  v_exp_f32 v14, v14
  v_exp_f32 v15, v15
  v_exp_f32 v16, v16
  v_exp_f32 v17, v17
  v_exp_f32 v18, v18
  v_exp_f32 v19, v19
  v_exp_f32 v20, v20
  v_exp_f32 v21, v21
  v_exp_f32 v22, v22
  v_exp_f32 v23, v23
  v_exp_f32 v24, v24
  v_exp_f32 v25, v25
  s_nop 1
  v_smfmac_f32_32x32x32_bf16 v[208:223], v[96:99], v[10:17], v44
  v_smfmac_f32_32x32x32_bf16 v[208:223], v[100:103], v[18:25], v44
  s_nop 7
  v_mfma_f32_32x32x16_bf16 v[10:25], v[80:83], v[72:75], 0
  s_nop 7
  s_nop 7
  v_sub_f32 v10, v10, v122
  v_sub_f32 v11, v11, v122
  v_sub_f32 v12, v12, v122
  v_sub_f32 v13, v13, v122
  v_sub_f32 v14, v14, v122
  v_sub_f32 v15, v15, v122
  v_sub_f32 v16, v16, v122
  v_sub_f32 v17, v17, v122
  v_sub_f32 v18, v18, v122
  v_sub_f32 v19, v19, v122
  v_sub_f32 v20, v20, v122
  v_sub_f32 v21, v21, v122
  v_sub_f32 v22, v22, v122
  v_sub_f32 v23, v23, v122
  v_sub_f32 v24, v24, v122
  v_sub_f32 v25, v25, v122
  v_exp_f32 v10, v10
  v_exp_f32 v11, v11
  v_exp_f32 v12, v12
  v_exp_f32 v13, v13
  v_exp_f32 v14, v14
  v_exp_f32 v15, v15
  v_exp_f32 v16, v16
  v_exp_f32 v17, v17
  v_exp_f32 v18, v18
  v_exp_f32 v19, v19
  v_exp_f32 v20, v20
  v_exp_f32 v21, v21
  v_exp_f32 v22, v22
  v_exp_f32 v23, v23
  v_exp_f32 v24, v24
  v_exp_f32 v25, v25
  s_nop 1
  v_smfmac_f32_32x32x32_bf16 v[224:239], v[96:99], v[10:17], v44
  v_smfmac_f32_32x32x32_bf16 v[224:239], v[100:103], v[18:25], v44
  s_nop 7
  v_mfma_f32_32x32x16_bf16 v[10:25], v[80:83], v[76:79], 0
  s_nop 7
  s_nop 7
  v_sub_f32 v10, v10, v123
  v_sub_f32 v11, v11, v123
  v_sub_f32 v12, v12, v123
  v_sub_f32 v13, v13, v123
  v_sub_f32 v14, v14, v123
  v_sub_f32 v15, v15, v123
  v_sub_f32 v16, v16, v123
  v_sub_f32 v17, v17, v123
  v_sub_f32 v18, v18, v123
  v_sub_f32 v19, v19, v123
  v_sub_f32 v20, v20, v123
  v_sub_f32 v21, v21, v123
  v_sub_f32 v22, v22, v123
  v_sub_f32 v23, v23, v123
  v_sub_f32 v24, v24, v123
  v_sub_f32 v25, v25, v123
  v_exp_f32 v10, v10
  v_exp_f32 v11, v11
  v_exp_f32 v12, v12
  v_exp_f32 v13, v13
  v_exp_f32 v14, v14
  v_exp_f32 v15, v15
  v_exp_f32 v16, v16
  v_exp_f32 v17, v17
  v_exp_f32 v18, v18
  v_exp_f32 v19, v19
  v_exp_f32 v20, v20
  v_exp_f32 v21, v21
  v_exp_f32 v22, v22
  v_exp_f32 v23, v23
  v_exp_f32 v24, v24
  v_exp_f32 v25, v25
  s_nop 1
  v_smfmac_f32_32x32x32_bf16 v[240:255], v[96:99], v[10:17], v44
  v_smfmac_f32_32x32x32_bf16 v[240:255], v[100:103], v[18:25], v44
  s_nop 7
  s_add_u32 s61, s61, 1024
  s_add_u32 s60, s60, 1024
  s_add_u32 s62, s62, 1
  s_cmp_lt_u32 s62, 16
  s_cbranch_scc1 K_S2
  v_mov_b32 v42, 159776
  v_mov_b32 v43, 1
  s_mov_b64 exec, 1
  ds_add_u32 v42, v43
  s_mov_b64 exec, -1
  s_waitcnt lgkmcnt(0)
  s_wakeup
  s_nop 7
  s_branch K_ATT_DONE
G2E_30:
  v_mov_b32 v46, 159776
  v_mov_b32 v47, 1
  s_mov_b64 exec, 1
  ds_add_u32 v46, v47
  s_mov_b64 exec, -1
  s_waitcnt lgkmcnt(0)
  s_wakeup
  s_branch G2EB_31
CHK_32:
  v_mov_b32 v42, 159780
GB_34:
  ds_read_b32 v43, v42
  s_waitcnt lgkmcnt(0)
  v_readfirstlane_b32 s3, v43
  s_nop 0
  s_cmp_ge_u32 s3, 1
  s_cbranch_scc0 GB_34
  s_cmp_eq_u32 s3, 2
  s_cbranch_scc1 K_SLOW
  v_mov_b32 v42, 159756
GB_35:
  ds_read_b32 v43, v42
  s_waitcnt lgkmcnt(0)
  v_readfirstlane_b32 s3, v43
  s_nop 0
  s_cmp_ge_u32 s3, 20
  s_cbranch_scc0 GB_35
  s_branch CHKB_33
RW_36:
  v_add_u32 v42, s56, v5
  v_add_u32 v43, s56, v9
  ds_write_b128 v42, v[128:131] offset:0
  ds_write_b128 v42, v[132:135] offset:1024
  ds_write_b32 v43, v136 offset:2048
  s_branch RWB_37
RW_38:
  v_add_u32 v42, s56, v5
  v_add_u32 v43, s56, v9
  ds_write_b128 v42, v[144:147] offset:6912
  ds_write_b128 v42, v[148:151] offset:7936
  ds_write_b32 v43, v152 offset:8960
  s_branch RWB_39
RW_40:
  v_add_u32 v42, s57, v5
  v_add_u32 v43, s57, v9
  ds_write_b128 v42, v[160:163] offset:0
  ds_write_b128 v42, v[164:167] offset:1024
  ds_write_b32 v43, v168 offset:2048
  s_branch RWB_41
RW_42:
  v_add_u32 v42, s57, v5
  v_add_u32 v43, s57, v9
  ds_write_b128 v42, v[176:179] offset:6912
  ds_write_b128 v42, v[180:183] offset:7936
  ds_write_b32 v43, v184 offset:8960
  s_branch RWB_43
RW_44:
  v_add_u32 v42, s58, v5
  v_add_u32 v43, s58, v9
  ds_write_b128 v42, v[192:195] offset:0
  ds_write_b128 v42, v[196:199] offset:1024
  ds_write_b32 v43, v200 offset:2048
  s_branch RWB_45
RW_46:
  v_add_u32 v42, s58, v5
  v_add_u32 v43, s58, v9
  ds_write_b128 v42, v[208:211] offset:6912
  ds_write_b128 v42, v[212:215] offset:7936
  ds_write_b32 v43, v216 offset:8960
  s_branch RWB_47
K_END:
  s_endpgm

.section .rodata,"a"
.p2align 6
.amdhsa_kernel parallel_sum__softmax_full_mha__mixer_channel_mlp__prompt_kernel
  .amdhsa_next_free_vgpr 256
  .amdhsa_next_free_sgpr 102
  .amdhsa_accum_offset 256
  .amdhsa_group_segment_fixed_size 0
  .amdhsa_kernarg_size 88
  .amdhsa_user_sgpr_count 2
  .amdhsa_user_sgpr_kernarg_segment_ptr 1
  .amdhsa_system_sgpr_workgroup_id_x 1
  .amdhsa_float_denorm_mode_32 3
.end_amdhsa_kernel
```
